```python
import torch

def _softmax(x, axis=-1):
    return torch.softmax(x, dim=axis)

def _gelu(x):
    return torch.nn.functional.gelu(x, approximate='tanh')

def _silu(x):
    return torch.nn.functional.silu(x)

def _sigmoid(x):
    return torch.sigmoid(x)

def _layernorm(x, axis=-1, eps=1e-05):
    m = x.mean(dim=axis, keepdim=True)
    v = x.var(dim=axis, keepdim=True, unbiased=False)
    return (x - m) / torch.sqrt(v + eps)

def _scatter_add(tgt, idx, src, axis=0):
    return tgt.clone().index_add_(axis, idx, src)

def _segment_sum(src, seg, n):
    out = torch.zeros((n,) + src.shape[1:], dtype=src.dtype)
    return out.index_add_(0, seg, src)

def _pad(x, pw):
    flat = tuple((v for pair in reversed(pw) for v in pair))
    return torch.nn.functional.pad(x, flat)
kernel_name = 'adaLN_cond__gqa_block_cached__swiglu_ffn__decode'

def setup_inputs():

    _w = lambda a: (lambda t: t.to(torch.bfloat16) if t.is_floating_point() else t)(torch.as_tensor(a))

    def _A_setup():
        B, Sq, D = (1, 1, 640)
        Hq, Hkv, Sk, Dh = (32, 32, 16384, 128)
        assert Hq % Hkv == 0, (Hq, Hkv)
        return {'x': _w((lambda *s: torch.randn(*s, dtype=torch.bfloat16) * 0.05)(B, Sq, D)), 'k_cache': _w((lambda *s: torch.randn(*s, dtype=torch.bfloat16) * 0.8)(B, Hkv, Sk, Dh)), 'v_cache': _w((lambda *s: torch.randn(*s, dtype=torch.bfloat16) * 1.6)(B, Hkv, Sk, Dh)), 'wq': _w((lambda *s: torch.randn(*s, dtype=torch.bfloat16) * 0.8)(D, Hq * Dh) * D ** (-0.5)), 'wo': _w((lambda *s: torch.randn(*s, dtype=torch.bfloat16) * 1.6)(Hq * Dh, D) * (Hq * Dh) ** (-0.5))}
    _A_in = _A_setup()

    def _B_setup():
        B, S, D, F = (1, 1, 640, 1728)
        return {'x': _w((lambda *s: torch.randn(*s, dtype=torch.bfloat16) * 0.05)(B, S, D)), 'w_gate': _w((lambda *s: torch.randn(*s, dtype=torch.bfloat16) * 0.05)(D, F)), 'w_up': _w((lambda *s: torch.randn(*s, dtype=torch.bfloat16) * 0.05)(D, F)), 'w_down': _w((lambda *s: torch.randn(*s, dtype=torch.bfloat16) * 0.05)(F, D))}
    _B_in = _B_setup()
    return {'A_x': _A_in['x'], 'A_k_cache': _A_in['k_cache'], 'A_v_cache': _A_in['v_cache'], 'A_wq': _A_in['wq'], 'A_wo': _A_in['wo'], 'B_x': _B_in['x'], 'B_w_gate': _B_in['w_gate'], 'B_w_up': _B_in['w_up'], 'B_w_down': _B_in['w_down'], 'c': _w((lambda *s: torch.randn(*s, dtype=torch.bfloat16) * 0.2)(1, 640) * 8.0), 'w_mod': _w((lambda *s: torch.randn(*s, dtype=torch.bfloat16) * 0.2)(640, 6 * 640) * 640 ** (-0.5) * 8.0)}

def reference(A_x, A_k_cache, A_v_cache, A_wq, A_wo, B_x, B_w_gate, B_w_up, B_w_down, c, w_mod):

    def _A_ref(x, k_cache, v_cache, wq, wo):
        B, Sq, D = x.shape
        Hq, Dh = (32, 128)
        Hkv = k_cache.shape[1]
        rep = Hq // Hkv
        q = (lambda x, *d: x.permute(*d))((x @ wq).reshape(B, Sq, Hq, Dh), 0, 2, 1, 3)
        k = (lambda x, n, axis: torch.repeat_interleave(x, n, dim=axis))(k_cache, rep, axis=1)
        v = (lambda x, n, axis: torch.repeat_interleave(x, n, dim=axis))(v_cache, rep, axis=1)
        scores = torch.einsum('bhqd,bhkd->bhqk', q, k) * Dh ** (-0.5)
        p = _softmax(scores, axis=-1)
        o = torch.einsum('bhqk,bhkd->bhqd', p, v)
        return (lambda x, *d: x.permute(*d))(o, 0, 2, 1, 3).reshape(B, Sq, Hq * Dh) @ wo

    def _B_ref(x, w_gate, w_up, w_down):
        g = _silu(x @ w_gate)
        u = x @ w_up
        return g * u @ w_down
    x = A_x
    mod = (_silu(c) @ w_mod).reshape(c.shape[0], 6, 1, -1)
    sa, ca, ga, sb, cb, gb = (mod[:, 0].clone(), mod[:, 1].clone(), mod[:, 2].clone(), mod[:, 3].clone(), mod[:, 4].clone(), mod[:, 5].clone())
    h = _layernorm(x, axis=-1) * (1 + ca) + sa
    x = x + ga * _A_ref(h, A_k_cache, A_v_cache, A_wq, A_wo)
    h = _layernorm(x, axis=-1) * (1 + cb) + sb
    x = x + gb * _B_ref(h, B_w_gate, B_w_up, B_w_down)
    return x
```

```asm
; @launch grid=(256,1,1) block=(512,1,1) lds=30720
.amdgcn_target "amdgcn-amd-amdhsa--gfx950"
.text
.globl adaLN_cond__gqa_block_cached__swiglu_ffn__decode_kernel
.p2align 8
.type adaLN_cond__gqa_block_cached__swiglu_ffn__decode_kernel,@function
adaLN_cond__gqa_block_cached__swiglu_ffn__decode_kernel:
    s_cmp_ge_u32 s2, 256
    s_cbranch_scc1 L_end
    s_load_dwordx16 s[4:19], s[0:1], 0
    s_load_dwordx8 s[20:27], s[0:1], 64
    s_load_dwordx4 s[28:31], s[0:1], 96
    v_lshrrev_b32 v1, 6, v0
    v_and_b32 v9, 63, v0
    v_readfirstlane_b32 s3, v1
    v_lshlrev_b32 v1, 4, v9
    s_lshr_b32 s32, s2, 3
    s_and_b32 s36, s2, 7
    s_lshl_b32 s35, s36, 2
    s_add_u32 s35, s35, s32
    s_and_b32 s35, s35, 31
    s_add_u32 s33, s36, s32
    s_and_b32 s33, s33, 7
    s_mov_b32 s62, 0x3fb8aa3b
    s_mov_b32 s63, 0x3db504f3
    s_sub_u32 s68, s35, 10
    s_mul_i32 s65, s36, 7
    s_add_u32 s65, s65, s68
    s_cmp_lt_u32 s68, 7
    s_cselect_b32 s65, s65, 63
    v_mov_b32 v2, 0
    v_mov_b32 v3, 1
    s_cmp_eq_u32 s3, 0
    s_cbranch_scc1 L_ctrl0
    s_cmp_gt_u32 s3, 5
    s_cbranch_scc1 L_help
    s_mul_i32 s37, s32, 304
    s_lshl_b32 s61, s33, 7
    s_add_u32 s61, s61, s37
    s_lshl_b32 s68, s32, 22
    s_add_u32 s67, s61, s3
    s_sub_u32 s67, s67, 1
    s_add_u32 s69, s67, 0
    s_and_b32 s69, s69, 1023
    s_lshl_b32 s69, s69, 12
    v_add_u32 v5, s69, v1
    s_waitcnt lgkmcnt(0)
    s_add_u32 s40, s6, s68
    s_addc_u32 s41, s7, 0
    s_mov_b32 s42, 0x400000
    s_mov_b32 s43, 0x20000
    buffer_load_dwordx4 v[64:67], v5, s[40:43], 0 offen offset:0 nt
    buffer_load_dwordx4 v[68:71], v5, s[40:43], 0 offen offset:1024 nt
    buffer_load_dwordx4 v[72:75], v5, s[40:43], 0 offen offset:2048 nt
    buffer_load_dwordx4 v[76:79], v5, s[40:43], 0 offen offset:3072 nt
    s_add_u32 s44, s8, s68
    s_addc_u32 s45, s9, 0
    s_mov_b32 s46, 0x400000
    s_mov_b32 s47, 0x20000
    s_barrier
    s_load_dword s34, s[30:31], 0
    s_mov_b32 s48, s30
    s_mov_b32 s49, s31
    s_mov_b32 s50, 3933184
    s_mov_b32 s51, 0x20000
    v_and_b32 v48, 1, v9
    v_lshlrev_b32 v48, 4, v48
    v_mov_b32 v49, 0xffff
    v_lshlrev_b32 v48, v48, v49
    v_bfe_u32 v49, v9, 1, 2
    v_bfe_u32 v50, v9, 1, 3
    v_cmp_eq_u32 vcc, 0, v49
    s_nop 1
    v_cndmask_b32 v60, 0, v48, vcc
    v_cmp_eq_u32 vcc, 0, v50
    s_nop 1
    v_cndmask_b32 v16, 0, v48, vcc
    v_cmp_eq_u32 vcc, 1, v49
    s_nop 1
    v_cndmask_b32 v61, 0, v48, vcc
    v_cmp_eq_u32 vcc, 2, v50
    s_nop 1
    v_cndmask_b32 v17, 0, v48, vcc
    v_cmp_eq_u32 vcc, 2, v49
    s_nop 1
    v_cndmask_b32 v62, 0, v48, vcc
    v_cmp_eq_u32 vcc, 4, v50
    s_nop 1
    v_cndmask_b32 v18, 0, v48, vcc
    v_cmp_eq_u32 vcc, 3, v49
    s_nop 1
    v_cndmask_b32 v63, 0, v48, vcc
    v_cmp_eq_u32 vcc, 6, v50
    s_nop 1
    v_cndmask_b32 v19, 0, v48, vcc
    v_and_b32 v48, 15, v9
    v_lshlrev_b32 v48, 6, v48
    v_and_b32 v49, 48, v9
    v_add_u32 v10, v48, v49
    s_waitcnt lgkmcnt(0)
    s_add_u32 s34, s34, 0x01010101
    s_lshl_b32 s38, s32, 8
    s_add_u32 s38, s38, 413696
    s_add_u32 s38, s38, s30
    s_addc_u32 s39, s31, 0
    s_mov_b32 s29, 64
    s_cmp_lt_u32 s65, 54
    s_cselect_b32 s29, 64, s29
    s_cmp_lt_u32 s35, 10
    s_cselect_b32 s29, 64, s29
    v_and_b32 v6, 60, v9
    s_lshl_b32 s68, s3, 6
    s_sub_u32 s68, s68, 64
    v_add_u32 v7, s68, v6
    v_mov_b32 v20, 0
    v_mov_b32 v21, 0
    v_mov_b32 v22, 0
    v_mov_b32 v23, 0
    s_add_u32 s69, s67, 5
    s_and_b32 s69, s69, 1023
    s_lshl_b32 s69, s69, 12
    v_add_u32 v5, s69, v1
    s_waitcnt vmcnt(0)
    buffer_load_dwordx4 v[80:83], v5, s[40:43], 0 offen offset:0 nt
    buffer_load_dwordx4 v[84:87], v5, s[40:43], 0 offen offset:1024 nt
    buffer_load_dwordx4 v[88:91], v5, s[40:43], 0 offen offset:2048 nt
    buffer_load_dwordx4 v[92:95], v5, s[40:43], 0 offen offset:3072 nt
    s_add_u32 s69, s67, 10
    s_and_b32 s69, s69, 1023
    s_lshl_b32 s69, s69, 12
    v_add_u32 v5, s69, v1
    s_waitcnt vmcnt(0)
    buffer_load_dwordx4 v[96:99], v5, s[40:43], 0 offen offset:0 nt
    buffer_load_dwordx4 v[100:103], v5, s[40:43], 0 offen offset:1024 nt
    buffer_load_dwordx4 v[104:107], v5, s[40:43], 0 offen offset:2048 nt
    buffer_load_dwordx4 v[108:111], v5, s[40:43], 0 offen offset:3072 nt
    s_add_u32 s69, s67, 15
    s_and_b32 s69, s69, 1023
    s_lshl_b32 s69, s69, 12
    v_add_u32 v5, s69, v1
    s_waitcnt vmcnt(0)
    buffer_load_dwordx4 v[112:115], v5, s[40:43], 0 offen offset:0 nt
    buffer_load_dwordx4 v[116:119], v5, s[40:43], 0 offen offset:1024 nt
    buffer_load_dwordx4 v[120:123], v5, s[40:43], 0 offen offset:2048 nt
    buffer_load_dwordx4 v[124:127], v5, s[40:43], 0 offen offset:3072 nt
    s_add_u32 s69, s67, 20
    s_and_b32 s69, s69, 1023
    s_lshl_b32 s69, s69, 12
    v_add_u32 v5, s69, v1
    s_waitcnt vmcnt(0)
    buffer_load_dwordx4 v[128:131], v5, s[40:43], 0 offen offset:0 nt
    buffer_load_dwordx4 v[132:135], v5, s[40:43], 0 offen offset:1024 nt
    buffer_load_dwordx4 v[136:139], v5, s[40:43], 0 offen offset:2048 nt
    buffer_load_dwordx4 v[140:143], v5, s[40:43], 0 offen offset:3072 nt
    s_add_u32 s69, s67, 25
    s_and_b32 s69, s69, 1023
    s_lshl_b32 s69, s69, 12
    v_add_u32 v5, s69, v1
    s_waitcnt vmcnt(0)
    buffer_load_dwordx4 v[144:147], v5, s[40:43], 0 offen offset:0 nt
    buffer_load_dwordx4 v[148:151], v5, s[40:43], 0 offen offset:1024 nt
    buffer_load_dwordx4 v[152:155], v5, s[40:43], 0 offen offset:2048 nt
    buffer_load_dwordx4 v[156:159], v5, s[40:43], 0 offen offset:3072 nt
    s_add_u32 s69, s67, 30
    s_and_b32 s69, s69, 1023
    s_lshl_b32 s69, s69, 12
    v_add_u32 v5, s69, v1
    s_waitcnt vmcnt(0)
    buffer_load_dwordx4 v[160:163], v5, s[40:43], 0 offen offset:0 nt
    buffer_load_dwordx4 v[164:167], v5, s[40:43], 0 offen offset:1024 nt
    buffer_load_dwordx4 v[168:171], v5, s[40:43], 0 offen offset:2048 nt
    buffer_load_dwordx4 v[172:175], v5, s[40:43], 0 offen offset:3072 nt
    s_add_u32 s69, s67, 35
    s_and_b32 s69, s69, 1023
    s_lshl_b32 s69, s69, 12
    v_add_u32 v5, s69, v1
    s_waitcnt vmcnt(0)
    buffer_load_dwordx4 v[176:179], v5, s[40:43], 0 offen offset:0 nt
    buffer_load_dwordx4 v[180:183], v5, s[40:43], 0 offen offset:1024 nt
    buffer_load_dwordx4 v[184:187], v5, s[40:43], 0 offen offset:2048 nt
    buffer_load_dwordx4 v[188:191], v5, s[40:43], 0 offen offset:3072 nt
    s_add_u32 s69, s67, 40
    s_and_b32 s69, s69, 1023
    s_lshl_b32 s69, s69, 12
    v_add_u32 v5, s69, v1
    s_waitcnt vmcnt(0)
    buffer_load_dwordx4 v[192:195], v5, s[40:43], 0 offen offset:0 nt
    buffer_load_dwordx4 v[196:199], v5, s[40:43], 0 offen offset:1024 nt
    buffer_load_dwordx4 v[200:203], v5, s[40:43], 0 offen offset:2048 nt
    buffer_load_dwordx4 v[204:207], v5, s[40:43], 0 offen offset:3072 nt
    s_add_u32 s69, s67, 45
    s_and_b32 s69, s69, 1023
    s_lshl_b32 s69, s69, 12
    v_add_u32 v5, s69, v1
    s_waitcnt vmcnt(0)
    buffer_load_dwordx4 v[208:211], v5, s[40:43], 0 offen offset:0 nt
    buffer_load_dwordx4 v[212:215], v5, s[40:43], 0 offen offset:1024 nt
    buffer_load_dwordx4 v[216:219], v5, s[40:43], 0 offen offset:2048 nt
    buffer_load_dwordx4 v[220:223], v5, s[40:43], 0 offen offset:3072 nt
    s_add_u32 s69, s67, 50
    s_and_b32 s69, s69, 1023
    s_lshl_b32 s69, s69, 12
    v_add_u32 v5, s69, v1
    s_waitcnt vmcnt(0)
    buffer_load_dwordx4 v[224:227], v5, s[40:43], 0 offen offset:0 nt
    buffer_load_dwordx4 v[228:231], v5, s[40:43], 0 offen offset:1024 nt
    buffer_load_dwordx4 v[232:235], v5, s[40:43], 0 offen offset:2048 nt
    buffer_load_dwordx4 v[236:239], v5, s[40:43], 0 offen offset:3072 nt
    s_add_u32 s69, s67, 55
    s_and_b32 s69, s69, 1023
    s_lshl_b32 s69, s69, 12
    v_add_u32 v5, s69, v1
    s_waitcnt vmcnt(0)
    buffer_load_dwordx4 v[240:243], v5, s[40:43], 0 offen offset:0 nt
    buffer_load_dwordx4 v[244:247], v5, s[40:43], 0 offen offset:1024 nt
    buffer_load_dwordx4 v[248:251], v5, s[40:43], 0 offen offset:2048 nt
    buffer_load_dwordx4 v[252:255], v5, s[40:43], 0 offen offset:3072 nt
    v_and_b32 v48, 15, v9
    v_lshlrev_b32 v48, 4, v48
    s_mov_b32 s64, 0x400000
L_lw_1:
    ds_read_b32 v11, v2 offset:8
    s_sub_u32 s64, s64, 1
    s_cmp_eq_u32 s64, 0
    s_cbranch_scc1 L_lwd_2
    s_waitcnt lgkmcnt(0)
    v_cmp_gt_u32 vcc, 1, v11
    s_cbranch_vccnz L_lw_1
L_lwd_2:
    ds_read_b128 v[12:15], v48 offset:256
    s_waitcnt lgkmcnt(0)
    v_dot2_f32_bf16 v24, v64, v12, 0
    v_dot2_f32_bf16 v25, v68, v12, 0
    v_dot2_f32_bf16 v26, v72, v12, 0
    v_dot2_f32_bf16 v27, v76, v12, 0
    v_dot2c_f32_bf16 v24, v65, v13
    v_dot2c_f32_bf16 v25, v69, v13
    v_dot2c_f32_bf16 v26, v73, v13
    v_dot2c_f32_bf16 v27, v77, v13
    v_dot2c_f32_bf16 v24, v66, v14
    v_dot2c_f32_bf16 v25, v70, v14
    v_dot2c_f32_bf16 v26, v74, v14
    v_dot2c_f32_bf16 v27, v78, v14
    v_dot2c_f32_bf16 v24, v67, v15
    v_dot2c_f32_bf16 v25, v71, v15
    v_dot2c_f32_bf16 v26, v75, v15
    v_dot2c_f32_bf16 v27, v79, v15
    v_add_f32_dpp v28, v24, v24 row_ror:8 row_mask:0xf bank_mask:0x3
    s_nop 0
    v_add_f32_dpp v29, v26, v26 row_ror:8 row_mask:0xf bank_mask:0x3
    v_add_f32_dpp v28, v25, v25 row_ror:8 row_mask:0xf bank_mask:0xc
    s_nop 0
    v_add_f32_dpp v29, v27, v27 row_ror:8 row_mask:0xf bank_mask:0xc
    v_add_f32_dpp v30, v28, v28 row_shl:4 row_mask:0xf bank_mask:0x5
    s_nop 1
    v_add_f32_dpp v30, v29, v29 row_shr:4 row_mask:0xf bank_mask:0xa
    s_nop 1
    v_add_f32_dpp v30, v30, v30 quad_perm:[1,0,3,2] row_mask:0xf bank_mask:0xf
    s_nop 1
    v_add_f32_dpp v30, v30, v30 quad_perm:[2,3,0,1] row_mask:0xf bank_mask:0xf
    v_cvt_pk_bf16_f32 v30, v30, v30
    v_and_b32 v30, 0xffff0000, v30
    v_mul_f32 v30, s63, v30
    v_cvt_pk_bf16_f32 v30, v30, v30
    v_and_b32 v30, 0xffff0000, v30
    ds_write_b32 v7, v30 offset:12288
    s_add_u32 s69, s67, 60
    s_and_b32 s69, s69, 1023
    s_lshl_b32 s69, s69, 12
    v_add_u32 v5, s69, v1
    s_waitcnt vmcnt(0)
    buffer_load_dwordx4 v[64:67], v5, s[40:43], 0 offen offset:0 nt
    buffer_load_dwordx4 v[68:71], v5, s[40:43], 0 offen offset:1024 nt
    buffer_load_dwordx4 v[72:75], v5, s[40:43], 0 offen offset:2048 nt
    buffer_load_dwordx4 v[76:79], v5, s[40:43], 0 offen offset:3072 nt
    v_dot2_f32_bf16 v24, v240, v12, 0
    v_dot2_f32_bf16 v25, v244, v12, 0
    v_dot2_f32_bf16 v26, v248, v12, 0
    v_dot2_f32_bf16 v27, v252, v12, 0
    v_dot2c_f32_bf16 v24, v241, v13
    v_dot2c_f32_bf16 v25, v245, v13
    v_dot2c_f32_bf16 v26, v249, v13
    v_dot2c_f32_bf16 v27, v253, v13
    v_dot2c_f32_bf16 v24, v242, v14
    v_dot2c_f32_bf16 v25, v246, v14
    v_dot2c_f32_bf16 v26, v250, v14
    v_dot2c_f32_bf16 v27, v254, v14
    v_dot2c_f32_bf16 v24, v243, v15
    v_dot2c_f32_bf16 v25, v247, v15
    v_dot2c_f32_bf16 v26, v251, v15
    v_dot2c_f32_bf16 v27, v255, v15
    v_add_f32_dpp v28, v24, v24 row_ror:8 row_mask:0xf bank_mask:0x3
    s_nop 0
    v_add_f32_dpp v29, v26, v26 row_ror:8 row_mask:0xf bank_mask:0x3
    v_add_f32_dpp v28, v25, v25 row_ror:8 row_mask:0xf bank_mask:0xc
    s_nop 0
    v_add_f32_dpp v29, v27, v27 row_ror:8 row_mask:0xf bank_mask:0xc
    v_add_f32_dpp v30, v28, v28 row_shl:4 row_mask:0xf bank_mask:0x5
    s_nop 1
    v_add_f32_dpp v30, v29, v29 row_shr:4 row_mask:0xf bank_mask:0xa
    s_nop 1
    v_add_f32_dpp v30, v30, v30 quad_perm:[1,0,3,2] row_mask:0xf bank_mask:0xf
    s_nop 1
    v_add_f32_dpp v30, v30, v30 quad_perm:[2,3,0,1] row_mask:0xf bank_mask:0xf
    v_cvt_pk_bf16_f32 v30, v30, v30
    v_and_b32 v30, 0xffff0000, v30
    v_mul_f32 v30, s63, v30
    v_cvt_pk_bf16_f32 v30, v30, v30
    v_and_b32 v30, 0xffff0000, v30
    ds_write_b32 v7, v30 offset:15808
    v_dot2_f32_bf16 v24, v80, v12, 0
    v_dot2_f32_bf16 v25, v84, v12, 0
    v_dot2_f32_bf16 v26, v88, v12, 0
    v_dot2_f32_bf16 v27, v92, v12, 0
    v_dot2c_f32_bf16 v24, v81, v13
    v_dot2c_f32_bf16 v25, v85, v13
    v_dot2c_f32_bf16 v26, v89, v13
    v_dot2c_f32_bf16 v27, v93, v13
    v_dot2c_f32_bf16 v24, v82, v14
    v_dot2c_f32_bf16 v25, v86, v14
    v_dot2c_f32_bf16 v26, v90, v14
    v_dot2c_f32_bf16 v27, v94, v14
    v_dot2c_f32_bf16 v24, v83, v15
    v_dot2c_f32_bf16 v25, v87, v15
    v_dot2c_f32_bf16 v26, v91, v15
    v_dot2c_f32_bf16 v27, v95, v15
    v_add_f32_dpp v28, v24, v24 row_ror:8 row_mask:0xf bank_mask:0x3
    s_nop 0
    v_add_f32_dpp v29, v26, v26 row_ror:8 row_mask:0xf bank_mask:0x3
    v_add_f32_dpp v28, v25, v25 row_ror:8 row_mask:0xf bank_mask:0xc
    s_nop 0
    v_add_f32_dpp v29, v27, v27 row_ror:8 row_mask:0xf bank_mask:0xc
    v_add_f32_dpp v30, v28, v28 row_shl:4 row_mask:0xf bank_mask:0x5
    s_nop 1
    v_add_f32_dpp v30, v29, v29 row_shr:4 row_mask:0xf bank_mask:0xa
    s_nop 1
    v_add_f32_dpp v30, v30, v30 quad_perm:[1,0,3,2] row_mask:0xf bank_mask:0xf
    s_nop 1
    v_add_f32_dpp v30, v30, v30 quad_perm:[2,3,0,1] row_mask:0xf bank_mask:0xf
    v_cvt_pk_bf16_f32 v30, v30, v30
    v_and_b32 v30, 0xffff0000, v30
    v_mul_f32 v30, s63, v30
    v_cvt_pk_bf16_f32 v30, v30, v30
    v_and_b32 v30, 0xffff0000, v30
    ds_write_b32 v7, v30 offset:12608
    v_dot2_f32_bf16 v24, v96, v12, 0
    v_dot2_f32_bf16 v25, v100, v12, 0
    v_dot2_f32_bf16 v26, v104, v12, 0
    v_dot2_f32_bf16 v27, v108, v12, 0
    v_dot2c_f32_bf16 v24, v97, v13
    v_dot2c_f32_bf16 v25, v101, v13
    v_dot2c_f32_bf16 v26, v105, v13
    v_dot2c_f32_bf16 v27, v109, v13
    v_dot2c_f32_bf16 v24, v98, v14
    v_dot2c_f32_bf16 v25, v102, v14
    v_dot2c_f32_bf16 v26, v106, v14
    v_dot2c_f32_bf16 v27, v110, v14
    v_dot2c_f32_bf16 v24, v99, v15
    v_dot2c_f32_bf16 v25, v103, v15
    v_dot2c_f32_bf16 v26, v107, v15
    v_dot2c_f32_bf16 v27, v111, v15
    v_add_f32_dpp v28, v24, v24 row_ror:8 row_mask:0xf bank_mask:0x3
    s_nop 0
    v_add_f32_dpp v29, v26, v26 row_ror:8 row_mask:0xf bank_mask:0x3
    v_add_f32_dpp v28, v25, v25 row_ror:8 row_mask:0xf bank_mask:0xc
    s_nop 0
    v_add_f32_dpp v29, v27, v27 row_ror:8 row_mask:0xf bank_mask:0xc
    v_add_f32_dpp v30, v28, v28 row_shl:4 row_mask:0xf bank_mask:0x5
    s_nop 1
    v_add_f32_dpp v30, v29, v29 row_shr:4 row_mask:0xf bank_mask:0xa
    s_nop 1
    v_add_f32_dpp v30, v30, v30 quad_perm:[1,0,3,2] row_mask:0xf bank_mask:0xf
    s_nop 1
    v_add_f32_dpp v30, v30, v30 quad_perm:[2,3,0,1] row_mask:0xf bank_mask:0xf
    v_cvt_pk_bf16_f32 v30, v30, v30
    v_and_b32 v30, 0xffff0000, v30
    v_mul_f32 v30, s63, v30
    v_cvt_pk_bf16_f32 v30, v30, v30
    v_and_b32 v30, 0xffff0000, v30
    ds_write_b32 v7, v30 offset:12928
    s_add_u32 s69, s67, 65
    s_and_b32 s69, s69, 1023
    s_lshl_b32 s69, s69, 12
    v_add_u32 v5, s69, v1
    s_waitcnt vmcnt(0)
    buffer_load_dwordx4 v[240:243], v5, s[40:43], 0 offen offset:0 nt
    buffer_load_dwordx4 v[244:247], v5, s[40:43], 0 offen offset:1024 nt
    buffer_load_dwordx4 v[248:251], v5, s[40:43], 0 offen offset:2048 nt
    buffer_load_dwordx4 v[252:255], v5, s[40:43], 0 offen offset:3072 nt
    v_dot2_f32_bf16 v24, v64, v12, 0
    v_dot2_f32_bf16 v25, v68, v12, 0
    v_dot2_f32_bf16 v26, v72, v12, 0
    v_dot2_f32_bf16 v27, v76, v12, 0
    v_dot2c_f32_bf16 v24, v65, v13
    v_dot2c_f32_bf16 v25, v69, v13
    v_dot2c_f32_bf16 v26, v73, v13
    v_dot2c_f32_bf16 v27, v77, v13
    v_dot2c_f32_bf16 v24, v66, v14
    v_dot2c_f32_bf16 v25, v70, v14
    v_dot2c_f32_bf16 v26, v74, v14
    v_dot2c_f32_bf16 v27, v78, v14
    v_dot2c_f32_bf16 v24, v67, v15
    v_dot2c_f32_bf16 v25, v71, v15
    v_dot2c_f32_bf16 v26, v75, v15
    v_dot2c_f32_bf16 v27, v79, v15
    v_add_f32_dpp v28, v24, v24 row_ror:8 row_mask:0xf bank_mask:0x3
    s_nop 0
    v_add_f32_dpp v29, v26, v26 row_ror:8 row_mask:0xf bank_mask:0x3
    v_add_f32_dpp v28, v25, v25 row_ror:8 row_mask:0xf bank_mask:0xc
    s_nop 0
    v_add_f32_dpp v29, v27, v27 row_ror:8 row_mask:0xf bank_mask:0xc
    v_add_f32_dpp v30, v28, v28 row_shl:4 row_mask:0xf bank_mask:0x5
    s_nop 1
    v_add_f32_dpp v30, v29, v29 row_shr:4 row_mask:0xf bank_mask:0xa
    s_nop 1
    v_add_f32_dpp v30, v30, v30 quad_perm:[1,0,3,2] row_mask:0xf bank_mask:0xf
    s_nop 1
    v_add_f32_dpp v30, v30, v30 quad_perm:[2,3,0,1] row_mask:0xf bank_mask:0xf
    v_cvt_pk_bf16_f32 v30, v30, v30
    v_and_b32 v30, 0xffff0000, v30
    v_mul_f32 v30, s63, v30
    v_cvt_pk_bf16_f32 v30, v30, v30
    v_and_b32 v30, 0xffff0000, v30
    ds_write_b32 v7, v30 offset:16128
    v_dot2_f32_bf16 v24, v112, v12, 0
    v_dot2_f32_bf16 v25, v116, v12, 0
    v_dot2_f32_bf16 v26, v120, v12, 0
    v_dot2_f32_bf16 v27, v124, v12, 0
    v_dot2c_f32_bf16 v24, v113, v13
    v_dot2c_f32_bf16 v25, v117, v13
    v_dot2c_f32_bf16 v26, v121, v13
    v_dot2c_f32_bf16 v27, v125, v13
    v_dot2c_f32_bf16 v24, v114, v14
    v_dot2c_f32_bf16 v25, v118, v14
    v_dot2c_f32_bf16 v26, v122, v14
    v_dot2c_f32_bf16 v27, v126, v14
    v_dot2c_f32_bf16 v24, v115, v15
    v_dot2c_f32_bf16 v25, v119, v15
    v_dot2c_f32_bf16 v26, v123, v15
    v_dot2c_f32_bf16 v27, v127, v15
    v_add_f32_dpp v28, v24, v24 row_ror:8 row_mask:0xf bank_mask:0x3
    s_nop 0
    v_add_f32_dpp v29, v26, v26 row_ror:8 row_mask:0xf bank_mask:0x3
    v_add_f32_dpp v28, v25, v25 row_ror:8 row_mask:0xf bank_mask:0xc
    s_nop 0
    v_add_f32_dpp v29, v27, v27 row_ror:8 row_mask:0xf bank_mask:0xc
    v_add_f32_dpp v30, v28, v28 row_shl:4 row_mask:0xf bank_mask:0x5
    s_nop 1
    v_add_f32_dpp v30, v29, v29 row_shr:4 row_mask:0xf bank_mask:0xa
    s_nop 1
    v_add_f32_dpp v30, v30, v30 quad_perm:[1,0,3,2] row_mask:0xf bank_mask:0xf
    s_nop 1
    v_add_f32_dpp v30, v30, v30 quad_perm:[2,3,0,1] row_mask:0xf bank_mask:0xf
    v_cvt_pk_bf16_f32 v30, v30, v30
    v_and_b32 v30, 0xffff0000, v30
    v_mul_f32 v30, s63, v30
    v_cvt_pk_bf16_f32 v30, v30, v30
    v_and_b32 v30, 0xffff0000, v30
    ds_write_b32 v7, v30 offset:13248
    v_dot2_f32_bf16 v24, v128, v12, 0
    v_dot2_f32_bf16 v25, v132, v12, 0
    v_dot2_f32_bf16 v26, v136, v12, 0
    v_dot2_f32_bf16 v27, v140, v12, 0
    v_dot2c_f32_bf16 v24, v129, v13
    v_dot2c_f32_bf16 v25, v133, v13
    v_dot2c_f32_bf16 v26, v137, v13
    v_dot2c_f32_bf16 v27, v141, v13
    v_dot2c_f32_bf16 v24, v130, v14
    v_dot2c_f32_bf16 v25, v134, v14
    v_dot2c_f32_bf16 v26, v138, v14
    v_dot2c_f32_bf16 v27, v142, v14
    v_dot2c_f32_bf16 v24, v131, v15
    v_dot2c_f32_bf16 v25, v135, v15
    v_dot2c_f32_bf16 v26, v139, v15
    v_dot2c_f32_bf16 v27, v143, v15
    v_add_f32_dpp v28, v24, v24 row_ror:8 row_mask:0xf bank_mask:0x3
    s_nop 0
    v_add_f32_dpp v29, v26, v26 row_ror:8 row_mask:0xf bank_mask:0x3
    v_add_f32_dpp v28, v25, v25 row_ror:8 row_mask:0xf bank_mask:0xc
    s_nop 0
    v_add_f32_dpp v29, v27, v27 row_ror:8 row_mask:0xf bank_mask:0xc
    v_add_f32_dpp v30, v28, v28 row_shl:4 row_mask:0xf bank_mask:0x5
    s_nop 1
    v_add_f32_dpp v30, v29, v29 row_shr:4 row_mask:0xf bank_mask:0xa
    s_nop 1
    v_add_f32_dpp v30, v30, v30 quad_perm:[1,0,3,2] row_mask:0xf bank_mask:0xf
    s_nop 1
    v_add_f32_dpp v30, v30, v30 quad_perm:[2,3,0,1] row_mask:0xf bank_mask:0xf
    v_cvt_pk_bf16_f32 v30, v30, v30
    v_and_b32 v30, 0xffff0000, v30
    v_mul_f32 v30, s63, v30
    v_cvt_pk_bf16_f32 v30, v30, v30
    v_and_b32 v30, 0xffff0000, v30
    ds_write_b32 v7, v30 offset:13568
    s_add_u32 s69, s67, 70
    s_and_b32 s69, s69, 1023
    s_lshl_b32 s69, s69, 12
    v_add_u32 v5, s69, v1
    s_waitcnt vmcnt(0)
    buffer_load_dwordx4 v[64:67], v5, s[40:43], 0 offen offset:0 nt
    buffer_load_dwordx4 v[68:71], v5, s[40:43], 0 offen offset:1024 nt
    buffer_load_dwordx4 v[72:75], v5, s[40:43], 0 offen offset:2048 nt
    buffer_load_dwordx4 v[76:79], v5, s[40:43], 0 offen offset:3072 nt
    v_dot2_f32_bf16 v24, v240, v12, 0
    v_dot2_f32_bf16 v25, v244, v12, 0
    v_dot2_f32_bf16 v26, v248, v12, 0
    v_dot2_f32_bf16 v27, v252, v12, 0
    v_dot2c_f32_bf16 v24, v241, v13
    v_dot2c_f32_bf16 v25, v245, v13
    v_dot2c_f32_bf16 v26, v249, v13
    v_dot2c_f32_bf16 v27, v253, v13
    v_dot2c_f32_bf16 v24, v242, v14
    v_dot2c_f32_bf16 v25, v246, v14
    v_dot2c_f32_bf16 v26, v250, v14
    v_dot2c_f32_bf16 v27, v254, v14
    v_dot2c_f32_bf16 v24, v243, v15
    v_dot2c_f32_bf16 v25, v247, v15
    v_dot2c_f32_bf16 v26, v251, v15
    v_dot2c_f32_bf16 v27, v255, v15
    v_add_f32_dpp v28, v24, v24 row_ror:8 row_mask:0xf bank_mask:0x3
    s_nop 0
    v_add_f32_dpp v29, v26, v26 row_ror:8 row_mask:0xf bank_mask:0x3
    v_add_f32_dpp v28, v25, v25 row_ror:8 row_mask:0xf bank_mask:0xc
    s_nop 0
    v_add_f32_dpp v29, v27, v27 row_ror:8 row_mask:0xf bank_mask:0xc
    v_add_f32_dpp v30, v28, v28 row_shl:4 row_mask:0xf bank_mask:0x5
    s_nop 1
    v_add_f32_dpp v30, v29, v29 row_shr:4 row_mask:0xf bank_mask:0xa
    s_nop 1
    v_add_f32_dpp v30, v30, v30 quad_perm:[1,0,3,2] row_mask:0xf bank_mask:0xf
    s_nop 1
    v_add_f32_dpp v30, v30, v30 quad_perm:[2,3,0,1] row_mask:0xf bank_mask:0xf
    v_cvt_pk_bf16_f32 v30, v30, v30
    v_and_b32 v30, 0xffff0000, v30
    v_mul_f32 v30, s63, v30
    v_cvt_pk_bf16_f32 v30, v30, v30
    v_and_b32 v30, 0xffff0000, v30
    ds_write_b32 v7, v30 offset:16448
    v_dot2_f32_bf16 v24, v144, v12, 0
    v_dot2_f32_bf16 v25, v148, v12, 0
    v_dot2_f32_bf16 v26, v152, v12, 0
    v_dot2_f32_bf16 v27, v156, v12, 0
    v_dot2c_f32_bf16 v24, v145, v13
    v_dot2c_f32_bf16 v25, v149, v13
    v_dot2c_f32_bf16 v26, v153, v13
    v_dot2c_f32_bf16 v27, v157, v13
    v_dot2c_f32_bf16 v24, v146, v14
    v_dot2c_f32_bf16 v25, v150, v14
    v_dot2c_f32_bf16 v26, v154, v14
    v_dot2c_f32_bf16 v27, v158, v14
    v_dot2c_f32_bf16 v24, v147, v15
    v_dot2c_f32_bf16 v25, v151, v15
    v_dot2c_f32_bf16 v26, v155, v15
    v_dot2c_f32_bf16 v27, v159, v15
    v_add_f32_dpp v28, v24, v24 row_ror:8 row_mask:0xf bank_mask:0x3
    s_nop 0
    v_add_f32_dpp v29, v26, v26 row_ror:8 row_mask:0xf bank_mask:0x3
    v_add_f32_dpp v28, v25, v25 row_ror:8 row_mask:0xf bank_mask:0xc
    s_nop 0
    v_add_f32_dpp v29, v27, v27 row_ror:8 row_mask:0xf bank_mask:0xc
    v_add_f32_dpp v30, v28, v28 row_shl:4 row_mask:0xf bank_mask:0x5
    s_nop 1
    v_add_f32_dpp v30, v29, v29 row_shr:4 row_mask:0xf bank_mask:0xa
    s_nop 1
    v_add_f32_dpp v30, v30, v30 quad_perm:[1,0,3,2] row_mask:0xf bank_mask:0xf
    s_nop 1
    v_add_f32_dpp v30, v30, v30 quad_perm:[2,3,0,1] row_mask:0xf bank_mask:0xf
    v_cvt_pk_bf16_f32 v30, v30, v30
    v_and_b32 v30, 0xffff0000, v30
    v_mul_f32 v30, s63, v30
    v_cvt_pk_bf16_f32 v30, v30, v30
    v_and_b32 v30, 0xffff0000, v30
    ds_write_b32 v7, v30 offset:13888
    v_dot2_f32_bf16 v24, v160, v12, 0
    v_dot2_f32_bf16 v25, v164, v12, 0
    v_dot2_f32_bf16 v26, v168, v12, 0
    v_dot2_f32_bf16 v27, v172, v12, 0
    v_dot2c_f32_bf16 v24, v161, v13
    v_dot2c_f32_bf16 v25, v165, v13
    v_dot2c_f32_bf16 v26, v169, v13
    v_dot2c_f32_bf16 v27, v173, v13
    v_dot2c_f32_bf16 v24, v162, v14
    v_dot2c_f32_bf16 v25, v166, v14
    v_dot2c_f32_bf16 v26, v170, v14
    v_dot2c_f32_bf16 v27, v174, v14
    v_dot2c_f32_bf16 v24, v163, v15
    v_dot2c_f32_bf16 v25, v167, v15
    v_dot2c_f32_bf16 v26, v171, v15
    v_dot2c_f32_bf16 v27, v175, v15
    v_add_f32_dpp v28, v24, v24 row_ror:8 row_mask:0xf bank_mask:0x3
    s_nop 0
    v_add_f32_dpp v29, v26, v26 row_ror:8 row_mask:0xf bank_mask:0x3
    v_add_f32_dpp v28, v25, v25 row_ror:8 row_mask:0xf bank_mask:0xc
    s_nop 0
    v_add_f32_dpp v29, v27, v27 row_ror:8 row_mask:0xf bank_mask:0xc
    v_add_f32_dpp v30, v28, v28 row_shl:4 row_mask:0xf bank_mask:0x5
    s_nop 1
    v_add_f32_dpp v30, v29, v29 row_shr:4 row_mask:0xf bank_mask:0xa
    s_nop 1
    v_add_f32_dpp v30, v30, v30 quad_perm:[1,0,3,2] row_mask:0xf bank_mask:0xf
    s_nop 1
    v_add_f32_dpp v30, v30, v30 quad_perm:[2,3,0,1] row_mask:0xf bank_mask:0xf
    v_cvt_pk_bf16_f32 v30, v30, v30
    v_and_b32 v30, 0xffff0000, v30
    v_mul_f32 v30, s63, v30
    v_cvt_pk_bf16_f32 v30, v30, v30
    v_and_b32 v30, 0xffff0000, v30
    ds_write_b32 v7, v30 offset:14208
    s_add_u32 s69, s67, 75
    s_and_b32 s69, s69, 1023
    s_lshl_b32 s69, s69, 12
    v_add_u32 v5, s69, v1
    s_waitcnt vmcnt(0)
    buffer_load_dwordx4 v[240:243], v5, s[40:43], 0 offen offset:0 nt
    buffer_load_dwordx4 v[244:247], v5, s[40:43], 0 offen offset:1024 nt
    buffer_load_dwordx4 v[248:251], v5, s[40:43], 0 offen offset:2048 nt
    buffer_load_dwordx4 v[252:255], v5, s[40:43], 0 offen offset:3072 nt
    v_dot2_f32_bf16 v24, v64, v12, 0
    v_dot2_f32_bf16 v25, v68, v12, 0
    v_dot2_f32_bf16 v26, v72, v12, 0
    v_dot2_f32_bf16 v27, v76, v12, 0
    v_dot2c_f32_bf16 v24, v65, v13
    v_dot2c_f32_bf16 v25, v69, v13
    v_dot2c_f32_bf16 v26, v73, v13
    v_dot2c_f32_bf16 v27, v77, v13
    v_dot2c_f32_bf16 v24, v66, v14
    v_dot2c_f32_bf16 v25, v70, v14
    v_dot2c_f32_bf16 v26, v74, v14
    v_dot2c_f32_bf16 v27, v78, v14
    v_dot2c_f32_bf16 v24, v67, v15
    v_dot2c_f32_bf16 v25, v71, v15
    v_dot2c_f32_bf16 v26, v75, v15
    v_dot2c_f32_bf16 v27, v79, v15
    v_add_f32_dpp v28, v24, v24 row_ror:8 row_mask:0xf bank_mask:0x3
    s_nop 0
    v_add_f32_dpp v29, v26, v26 row_ror:8 row_mask:0xf bank_mask:0x3
    v_add_f32_dpp v28, v25, v25 row_ror:8 row_mask:0xf bank_mask:0xc
    s_nop 0
    v_add_f32_dpp v29, v27, v27 row_ror:8 row_mask:0xf bank_mask:0xc
    v_add_f32_dpp v30, v28, v28 row_shl:4 row_mask:0xf bank_mask:0x5
    s_nop 1
    v_add_f32_dpp v30, v29, v29 row_shr:4 row_mask:0xf bank_mask:0xa
    s_nop 1
    v_add_f32_dpp v30, v30, v30 quad_perm:[1,0,3,2] row_mask:0xf bank_mask:0xf
    s_nop 1
    v_add_f32_dpp v30, v30, v30 quad_perm:[2,3,0,1] row_mask:0xf bank_mask:0xf
    v_cvt_pk_bf16_f32 v30, v30, v30
    v_and_b32 v30, 0xffff0000, v30
    v_mul_f32 v30, s63, v30
    v_cvt_pk_bf16_f32 v30, v30, v30
    v_and_b32 v30, 0xffff0000, v30
    ds_write_b32 v7, v30 offset:16768
    v_dot2_f32_bf16 v24, v176, v12, 0
    v_dot2_f32_bf16 v25, v180, v12, 0
    v_dot2_f32_bf16 v26, v184, v12, 0
    v_dot2_f32_bf16 v27, v188, v12, 0
    v_dot2c_f32_bf16 v24, v177, v13
    v_dot2c_f32_bf16 v25, v181, v13
    v_dot2c_f32_bf16 v26, v185, v13
    v_dot2c_f32_bf16 v27, v189, v13
    v_dot2c_f32_bf16 v24, v178, v14
    v_dot2c_f32_bf16 v25, v182, v14
    v_dot2c_f32_bf16 v26, v186, v14
    v_dot2c_f32_bf16 v27, v190, v14
    v_dot2c_f32_bf16 v24, v179, v15
    v_dot2c_f32_bf16 v25, v183, v15
    v_dot2c_f32_bf16 v26, v187, v15
    v_dot2c_f32_bf16 v27, v191, v15
    v_add_f32_dpp v28, v24, v24 row_ror:8 row_mask:0xf bank_mask:0x3
    s_nop 0
    v_add_f32_dpp v29, v26, v26 row_ror:8 row_mask:0xf bank_mask:0x3
    v_add_f32_dpp v28, v25, v25 row_ror:8 row_mask:0xf bank_mask:0xc
    s_nop 0
    v_add_f32_dpp v29, v27, v27 row_ror:8 row_mask:0xf bank_mask:0xc
    v_add_f32_dpp v30, v28, v28 row_shl:4 row_mask:0xf bank_mask:0x5
    s_nop 1
    v_add_f32_dpp v30, v29, v29 row_shr:4 row_mask:0xf bank_mask:0xa
    s_nop 1
    v_add_f32_dpp v30, v30, v30 quad_perm:[1,0,3,2] row_mask:0xf bank_mask:0xf
    s_nop 1
    v_add_f32_dpp v30, v30, v30 quad_perm:[2,3,0,1] row_mask:0xf bank_mask:0xf
    v_cvt_pk_bf16_f32 v30, v30, v30
    v_and_b32 v30, 0xffff0000, v30
    v_mul_f32 v30, s63, v30
    v_cvt_pk_bf16_f32 v30, v30, v30
    v_and_b32 v30, 0xffff0000, v30
    ds_write_b32 v7, v30 offset:14528
    v_dot2_f32_bf16 v24, v192, v12, 0
    v_dot2_f32_bf16 v25, v196, v12, 0
    v_dot2_f32_bf16 v26, v200, v12, 0
    v_dot2_f32_bf16 v27, v204, v12, 0
    v_dot2c_f32_bf16 v24, v193, v13
    v_dot2c_f32_bf16 v25, v197, v13
    v_dot2c_f32_bf16 v26, v201, v13
    v_dot2c_f32_bf16 v27, v205, v13
    v_dot2c_f32_bf16 v24, v194, v14
    v_dot2c_f32_bf16 v25, v198, v14
    v_dot2c_f32_bf16 v26, v202, v14
    v_dot2c_f32_bf16 v27, v206, v14
    v_dot2c_f32_bf16 v24, v195, v15
    v_dot2c_f32_bf16 v25, v199, v15
    v_dot2c_f32_bf16 v26, v203, v15
    v_dot2c_f32_bf16 v27, v207, v15
    v_add_f32_dpp v28, v24, v24 row_ror:8 row_mask:0xf bank_mask:0x3
    s_nop 0
    v_add_f32_dpp v29, v26, v26 row_ror:8 row_mask:0xf bank_mask:0x3
    v_add_f32_dpp v28, v25, v25 row_ror:8 row_mask:0xf bank_mask:0xc
    s_nop 0
    v_add_f32_dpp v29, v27, v27 row_ror:8 row_mask:0xf bank_mask:0xc
    v_add_f32_dpp v30, v28, v28 row_shl:4 row_mask:0xf bank_mask:0x5
    s_nop 1
    v_add_f32_dpp v30, v29, v29 row_shr:4 row_mask:0xf bank_mask:0xa
    s_nop 1
    v_add_f32_dpp v30, v30, v30 quad_perm:[1,0,3,2] row_mask:0xf bank_mask:0xf
    s_nop 1
    v_add_f32_dpp v30, v30, v30 quad_perm:[2,3,0,1] row_mask:0xf bank_mask:0xf
    v_cvt_pk_bf16_f32 v30, v30, v30
    v_and_b32 v30, 0xffff0000, v30
    v_mul_f32 v30, s63, v30
    v_cvt_pk_bf16_f32 v30, v30, v30
    v_and_b32 v30, 0xffff0000, v30
    ds_write_b32 v7, v30 offset:14848
    s_add_u32 s69, s67, 80
    s_and_b32 s69, s69, 1023
    s_lshl_b32 s69, s69, 12
    v_add_u32 v5, s69, v1
    s_waitcnt vmcnt(0)
    buffer_load_dwordx4 v[64:67], v5, s[40:43], 0 offen offset:0 nt
    buffer_load_dwordx4 v[68:71], v5, s[40:43], 0 offen offset:1024 nt
    buffer_load_dwordx4 v[72:75], v5, s[40:43], 0 offen offset:2048 nt
    buffer_load_dwordx4 v[76:79], v5, s[40:43], 0 offen offset:3072 nt
    s_mov_b64 exec, 1
    ds_add_rtn_u32 v4, v2, v3 offset:0
    s_mov_b64 exec, -1
    v_dot2_f32_bf16 v24, v240, v12, 0
    v_dot2_f32_bf16 v25, v244, v12, 0
    v_dot2_f32_bf16 v26, v248, v12, 0
    v_dot2_f32_bf16 v27, v252, v12, 0
    v_dot2c_f32_bf16 v24, v241, v13
    v_dot2c_f32_bf16 v25, v245, v13
    v_dot2c_f32_bf16 v26, v249, v13
    v_dot2c_f32_bf16 v27, v253, v13
    v_dot2c_f32_bf16 v24, v242, v14
    v_dot2c_f32_bf16 v25, v246, v14
    v_dot2c_f32_bf16 v26, v250, v14
    v_dot2c_f32_bf16 v27, v254, v14
    v_dot2c_f32_bf16 v24, v243, v15
    v_dot2c_f32_bf16 v25, v247, v15
    v_dot2c_f32_bf16 v26, v251, v15
    v_dot2c_f32_bf16 v27, v255, v15
    v_add_f32_dpp v28, v24, v24 row_ror:8 row_mask:0xf bank_mask:0x3
    s_nop 0
    v_add_f32_dpp v29, v26, v26 row_ror:8 row_mask:0xf bank_mask:0x3
    v_add_f32_dpp v28, v25, v25 row_ror:8 row_mask:0xf bank_mask:0xc
    s_nop 0
    v_add_f32_dpp v29, v27, v27 row_ror:8 row_mask:0xf bank_mask:0xc
    v_add_f32_dpp v30, v28, v28 row_shl:4 row_mask:0xf bank_mask:0x5
    s_nop 1
    v_add_f32_dpp v30, v29, v29 row_shr:4 row_mask:0xf bank_mask:0xa
    s_nop 1
    v_add_f32_dpp v30, v30, v30 quad_perm:[1,0,3,2] row_mask:0xf bank_mask:0xf
    s_nop 1
    v_add_f32_dpp v30, v30, v30 quad_perm:[2,3,0,1] row_mask:0xf bank_mask:0xf
    v_cvt_pk_bf16_f32 v30, v30, v30
    v_and_b32 v30, 0xffff0000, v30
    v_mul_f32 v30, s63, v30
    v_cvt_pk_bf16_f32 v30, v30, v30
    v_and_b32 v30, 0xffff0000, v30
    ds_write_b32 v7, v30 offset:17088
    v_dot2_f32_bf16 v24, v208, v12, 0
    v_dot2_f32_bf16 v25, v212, v12, 0
    v_dot2_f32_bf16 v26, v216, v12, 0
    v_dot2_f32_bf16 v27, v220, v12, 0
    v_dot2c_f32_bf16 v24, v209, v13
    v_dot2c_f32_bf16 v25, v213, v13
    v_dot2c_f32_bf16 v26, v217, v13
    v_dot2c_f32_bf16 v27, v221, v13
    v_dot2c_f32_bf16 v24, v210, v14
    v_dot2c_f32_bf16 v25, v214, v14
    v_dot2c_f32_bf16 v26, v218, v14
    v_dot2c_f32_bf16 v27, v222, v14
    v_dot2c_f32_bf16 v24, v211, v15
    v_dot2c_f32_bf16 v25, v215, v15
    v_dot2c_f32_bf16 v26, v219, v15
    v_dot2c_f32_bf16 v27, v223, v15
    v_add_f32_dpp v28, v24, v24 row_ror:8 row_mask:0xf bank_mask:0x3
    s_nop 0
    v_add_f32_dpp v29, v26, v26 row_ror:8 row_mask:0xf bank_mask:0x3
    v_add_f32_dpp v28, v25, v25 row_ror:8 row_mask:0xf bank_mask:0xc
    s_nop 0
    v_add_f32_dpp v29, v27, v27 row_ror:8 row_mask:0xf bank_mask:0xc
    v_add_f32_dpp v30, v28, v28 row_shl:4 row_mask:0xf bank_mask:0x5
    s_nop 1
    v_add_f32_dpp v30, v29, v29 row_shr:4 row_mask:0xf bank_mask:0xa
    s_nop 1
    v_add_f32_dpp v30, v30, v30 quad_perm:[1,0,3,2] row_mask:0xf bank_mask:0xf
    s_nop 1
    v_add_f32_dpp v30, v30, v30 quad_perm:[2,3,0,1] row_mask:0xf bank_mask:0xf
    v_cvt_pk_bf16_f32 v30, v30, v30
    v_and_b32 v30, 0xffff0000, v30
    v_mul_f32 v30, s63, v30
    v_cvt_pk_bf16_f32 v30, v30, v30
    v_and_b32 v30, 0xffff0000, v30
    ds_write_b32 v7, v30 offset:15168
    v_dot2_f32_bf16 v24, v224, v12, 0
    v_dot2_f32_bf16 v25, v228, v12, 0
    v_dot2_f32_bf16 v26, v232, v12, 0
    v_dot2_f32_bf16 v27, v236, v12, 0
    v_dot2c_f32_bf16 v24, v225, v13
    v_dot2c_f32_bf16 v25, v229, v13
    v_dot2c_f32_bf16 v26, v233, v13
    v_dot2c_f32_bf16 v27, v237, v13
    v_dot2c_f32_bf16 v24, v226, v14
    v_dot2c_f32_bf16 v25, v230, v14
    v_dot2c_f32_bf16 v26, v234, v14
    v_dot2c_f32_bf16 v27, v238, v14
    v_dot2c_f32_bf16 v24, v227, v15
    v_dot2c_f32_bf16 v25, v231, v15
    v_dot2c_f32_bf16 v26, v235, v15
    v_dot2c_f32_bf16 v27, v239, v15
    v_add_f32_dpp v28, v24, v24 row_ror:8 row_mask:0xf bank_mask:0x3
    s_nop 0
    v_add_f32_dpp v29, v26, v26 row_ror:8 row_mask:0xf bank_mask:0x3
    v_add_f32_dpp v28, v25, v25 row_ror:8 row_mask:0xf bank_mask:0xc
    s_nop 0
    v_add_f32_dpp v29, v27, v27 row_ror:8 row_mask:0xf bank_mask:0xc
    v_add_f32_dpp v30, v28, v28 row_shl:4 row_mask:0xf bank_mask:0x5
    s_nop 1
    v_add_f32_dpp v30, v29, v29 row_shr:4 row_mask:0xf bank_mask:0xa
    s_nop 1
    v_add_f32_dpp v30, v30, v30 quad_perm:[1,0,3,2] row_mask:0xf bank_mask:0xf
    s_nop 1
    v_add_f32_dpp v30, v30, v30 quad_perm:[2,3,0,1] row_mask:0xf bank_mask:0xf
    v_cvt_pk_bf16_f32 v30, v30, v30
    v_and_b32 v30, 0xffff0000, v30
    v_mul_f32 v30, s63, v30
    v_cvt_pk_bf16_f32 v30, v30, v30
    v_and_b32 v30, 0xffff0000, v30
    ds_write_b32 v7, v30 offset:15488
    v_add_u32 v31, 5120, v7
L_k0:
    s_waitcnt lgkmcnt(0)
    v_readfirstlane_b32 s66, v4
    s_cmp_ge_u32 s66, 128
    s_cbranch_scc1 L_kend0
    s_add_u32 s69, s66, s61
    s_and_b32 s69, s69, 1023
    s_lshl_b32 s69, s69, 12
    v_add_u32 v5, s69, v1
    s_waitcnt vmcnt(0)
    buffer_load_dwordx4 v[240:243], v5, s[40:43], 0 offen offset:0 nt
    buffer_load_dwordx4 v[244:247], v5, s[40:43], 0 offen offset:1024 nt
    buffer_load_dwordx4 v[248:251], v5, s[40:43], 0 offen offset:2048 nt
    buffer_load_dwordx4 v[252:255], v5, s[40:43], 0 offen offset:3072 nt
    s_mov_b64 exec, 1
    ds_add_rtn_u32 v4, v2, v3 offset:0
    s_mov_b64 exec, -1
    v_dot2_f32_bf16 v24, v64, v12, 0
    v_dot2_f32_bf16 v25, v68, v12, 0
    v_dot2_f32_bf16 v26, v72, v12, 0
    v_dot2_f32_bf16 v27, v76, v12, 0
    v_dot2c_f32_bf16 v24, v65, v13
    v_dot2c_f32_bf16 v25, v69, v13
    v_dot2c_f32_bf16 v26, v73, v13
    v_dot2c_f32_bf16 v27, v77, v13
    v_dot2c_f32_bf16 v24, v66, v14
    v_dot2c_f32_bf16 v25, v70, v14
    v_dot2c_f32_bf16 v26, v74, v14
    v_dot2c_f32_bf16 v27, v78, v14
    v_dot2c_f32_bf16 v24, v67, v15
    v_dot2c_f32_bf16 v25, v71, v15
    v_dot2c_f32_bf16 v26, v75, v15
    v_dot2c_f32_bf16 v27, v79, v15
    v_add_f32_dpp v28, v24, v24 row_ror:8 row_mask:0xf bank_mask:0x3
    s_nop 0
    v_add_f32_dpp v29, v26, v26 row_ror:8 row_mask:0xf bank_mask:0x3
    v_add_f32_dpp v28, v25, v25 row_ror:8 row_mask:0xf bank_mask:0xc
    s_nop 0
    v_add_f32_dpp v29, v27, v27 row_ror:8 row_mask:0xf bank_mask:0xc
    v_add_f32_dpp v30, v28, v28 row_shl:4 row_mask:0xf bank_mask:0x5
    s_nop 1
    v_add_f32_dpp v30, v29, v29 row_shr:4 row_mask:0xf bank_mask:0xa
    s_nop 1
    v_add_f32_dpp v30, v30, v30 quad_perm:[1,0,3,2] row_mask:0xf bank_mask:0xf
    s_nop 1
    v_add_f32_dpp v30, v30, v30 quad_perm:[2,3,0,1] row_mask:0xf bank_mask:0xf
    v_cvt_pk_bf16_f32 v30, v30, v30
    v_and_b32 v30, 0xffff0000, v30
    v_mul_f32 v30, s63, v30
    v_cvt_pk_bf16_f32 v30, v30, v30
    v_and_b32 v30, 0xffff0000, v30
    ds_write_b32 v31, v30 offset:12288
    s_lshl_b32 s68, s66, 6
    v_add_u32 v31, s68, v6
L_k1:
    s_waitcnt lgkmcnt(0)
    v_readfirstlane_b32 s66, v4
    s_cmp_ge_u32 s66, 128
    s_cbranch_scc1 L_kend1
    s_add_u32 s69, s66, s61
    s_and_b32 s69, s69, 1023
    s_lshl_b32 s69, s69, 12
    v_add_u32 v5, s69, v1
    s_waitcnt vmcnt(0)
    buffer_load_dwordx4 v[64:67], v5, s[40:43], 0 offen offset:0 nt
    buffer_load_dwordx4 v[68:71], v5, s[40:43], 0 offen offset:1024 nt
    buffer_load_dwordx4 v[72:75], v5, s[40:43], 0 offen offset:2048 nt
    buffer_load_dwordx4 v[76:79], v5, s[40:43], 0 offen offset:3072 nt
    s_mov_b64 exec, 1
    ds_add_rtn_u32 v4, v2, v3 offset:0
    s_mov_b64 exec, -1
    v_dot2_f32_bf16 v24, v240, v12, 0
    v_dot2_f32_bf16 v25, v244, v12, 0
    v_dot2_f32_bf16 v26, v248, v12, 0
    v_dot2_f32_bf16 v27, v252, v12, 0
    v_dot2c_f32_bf16 v24, v241, v13
    v_dot2c_f32_bf16 v25, v245, v13
    v_dot2c_f32_bf16 v26, v249, v13
    v_dot2c_f32_bf16 v27, v253, v13
    v_dot2c_f32_bf16 v24, v242, v14
    v_dot2c_f32_bf16 v25, v246, v14
    v_dot2c_f32_bf16 v26, v250, v14
    v_dot2c_f32_bf16 v27, v254, v14
    v_dot2c_f32_bf16 v24, v243, v15
    v_dot2c_f32_bf16 v25, v247, v15
    v_dot2c_f32_bf16 v26, v251, v15
    v_dot2c_f32_bf16 v27, v255, v15
    v_add_f32_dpp v28, v24, v24 row_ror:8 row_mask:0xf bank_mask:0x3
    s_nop 0
    v_add_f32_dpp v29, v26, v26 row_ror:8 row_mask:0xf bank_mask:0x3
    v_add_f32_dpp v28, v25, v25 row_ror:8 row_mask:0xf bank_mask:0xc
    s_nop 0
    v_add_f32_dpp v29, v27, v27 row_ror:8 row_mask:0xf bank_mask:0xc
    v_add_f32_dpp v30, v28, v28 row_shl:4 row_mask:0xf bank_mask:0x5
    s_nop 1
    v_add_f32_dpp v30, v29, v29 row_shr:4 row_mask:0xf bank_mask:0xa
    s_nop 1
    v_add_f32_dpp v30, v30, v30 quad_perm:[1,0,3,2] row_mask:0xf bank_mask:0xf
    s_nop 1
    v_add_f32_dpp v30, v30, v30 quad_perm:[2,3,0,1] row_mask:0xf bank_mask:0xf
    v_cvt_pk_bf16_f32 v30, v30, v30
    v_and_b32 v30, 0xffff0000, v30
    v_mul_f32 v30, s63, v30
    v_cvt_pk_bf16_f32 v30, v30, v30
    v_and_b32 v30, 0xffff0000, v30
    ds_write_b32 v31, v30 offset:12288
    s_lshl_b32 s68, s66, 6
    v_add_u32 v31, s68, v6
    s_branch L_k0
L_kend0:
    s_add_u32 s69, s67, 0
    s_and_b32 s69, s69, 1023
    s_lshl_b32 s69, s69, 12
    v_add_u32 v5, s69, v1
    s_waitcnt vmcnt(0)
    buffer_load_dwordx4 v[80:83], v5, s[44:47], 0 offen offset:0 nt
    buffer_load_dwordx4 v[84:87], v5, s[44:47], 0 offen offset:1024 nt
    buffer_load_dwordx4 v[88:91], v5, s[44:47], 0 offen offset:2048 nt
    buffer_load_dwordx4 v[92:95], v5, s[44:47], 0 offen offset:3072 nt
    v_dot2_f32_bf16 v24, v64, v12, 0
    v_dot2_f32_bf16 v25, v68, v12, 0
    v_dot2_f32_bf16 v26, v72, v12, 0
    v_dot2_f32_bf16 v27, v76, v12, 0
    v_dot2c_f32_bf16 v24, v65, v13
    v_dot2c_f32_bf16 v25, v69, v13
    v_dot2c_f32_bf16 v26, v73, v13
    v_dot2c_f32_bf16 v27, v77, v13
    v_dot2c_f32_bf16 v24, v66, v14
    v_dot2c_f32_bf16 v25, v70, v14
    v_dot2c_f32_bf16 v26, v74, v14
    v_dot2c_f32_bf16 v27, v78, v14
    v_dot2c_f32_bf16 v24, v67, v15
    v_dot2c_f32_bf16 v25, v71, v15
    v_dot2c_f32_bf16 v26, v75, v15
    v_dot2c_f32_bf16 v27, v79, v15
    v_add_f32_dpp v28, v24, v24 row_ror:8 row_mask:0xf bank_mask:0x3
    s_nop 0
    v_add_f32_dpp v29, v26, v26 row_ror:8 row_mask:0xf bank_mask:0x3
    v_add_f32_dpp v28, v25, v25 row_ror:8 row_mask:0xf bank_mask:0xc
    s_nop 0
    v_add_f32_dpp v29, v27, v27 row_ror:8 row_mask:0xf bank_mask:0xc
    v_add_f32_dpp v30, v28, v28 row_shl:4 row_mask:0xf bank_mask:0x5
    s_nop 1
    v_add_f32_dpp v30, v29, v29 row_shr:4 row_mask:0xf bank_mask:0xa
    s_nop 1
    v_add_f32_dpp v30, v30, v30 quad_perm:[1,0,3,2] row_mask:0xf bank_mask:0xf
    s_nop 1
    v_add_f32_dpp v30, v30, v30 quad_perm:[2,3,0,1] row_mask:0xf bank_mask:0xf
    v_cvt_pk_bf16_f32 v30, v30, v30
    v_and_b32 v30, 0xffff0000, v30
    v_mul_f32 v30, s63, v30
    v_cvt_pk_bf16_f32 v30, v30, v30
    v_and_b32 v30, 0xffff0000, v30
    ds_write_b32 v31, v30 offset:12288
    s_branch L_vpre
L_kend1:
    s_add_u32 s69, s67, 0
    s_and_b32 s69, s69, 1023
    s_lshl_b32 s69, s69, 12
    v_add_u32 v5, s69, v1
    s_waitcnt vmcnt(0)
    buffer_load_dwordx4 v[80:83], v5, s[44:47], 0 offen offset:0 nt
    buffer_load_dwordx4 v[84:87], v5, s[44:47], 0 offen offset:1024 nt
    buffer_load_dwordx4 v[88:91], v5, s[44:47], 0 offen offset:2048 nt
    buffer_load_dwordx4 v[92:95], v5, s[44:47], 0 offen offset:3072 nt
    v_dot2_f32_bf16 v24, v240, v12, 0
    v_dot2_f32_bf16 v25, v244, v12, 0
    v_dot2_f32_bf16 v26, v248, v12, 0
    v_dot2_f32_bf16 v27, v252, v12, 0
    v_dot2c_f32_bf16 v24, v241, v13
    v_dot2c_f32_bf16 v25, v245, v13
    v_dot2c_f32_bf16 v26, v249, v13
    v_dot2c_f32_bf16 v27, v253, v13
    v_dot2c_f32_bf16 v24, v242, v14
    v_dot2c_f32_bf16 v25, v246, v14
    v_dot2c_f32_bf16 v26, v250, v14
    v_dot2c_f32_bf16 v27, v254, v14
    v_dot2c_f32_bf16 v24, v243, v15
    v_dot2c_f32_bf16 v25, v247, v15
    v_dot2c_f32_bf16 v26, v251, v15
    v_dot2c_f32_bf16 v27, v255, v15
    v_add_f32_dpp v28, v24, v24 row_ror:8 row_mask:0xf bank_mask:0x3
    s_nop 0
    v_add_f32_dpp v29, v26, v26 row_ror:8 row_mask:0xf bank_mask:0x3
    v_add_f32_dpp v28, v25, v25 row_ror:8 row_mask:0xf bank_mask:0xc
    s_nop 0
    v_add_f32_dpp v29, v27, v27 row_ror:8 row_mask:0xf bank_mask:0xc
    v_add_f32_dpp v30, v28, v28 row_shl:4 row_mask:0xf bank_mask:0x5
    s_nop 1
    v_add_f32_dpp v30, v29, v29 row_shr:4 row_mask:0xf bank_mask:0xa
    s_nop 1
    v_add_f32_dpp v30, v30, v30 quad_perm:[1,0,3,2] row_mask:0xf bank_mask:0xf
    s_nop 1
    v_add_f32_dpp v30, v30, v30 quad_perm:[2,3,0,1] row_mask:0xf bank_mask:0xf
    v_cvt_pk_bf16_f32 v30, v30, v30
    v_and_b32 v30, 0xffff0000, v30
    v_mul_f32 v30, s63, v30
    v_cvt_pk_bf16_f32 v30, v30, v30
    v_and_b32 v30, 0xffff0000, v30
    ds_write_b32 v31, v30 offset:12288
L_vpre:
    s_waitcnt lgkmcnt(0)
    s_mov_b64 exec, 1
    ds_add_u32 v2, v3 offset:16
    s_mov_b64 exec, -1
    s_add_u32 s69, s67, 5
    s_and_b32 s69, s69, 1023
    s_lshl_b32 s69, s69, 12
    v_add_u32 v5, s69, v1
    s_waitcnt vmcnt(0)
    buffer_load_dwordx4 v[96:99], v5, s[44:47], 0 offen offset:0 nt
    buffer_load_dwordx4 v[100:103], v5, s[44:47], 0 offen offset:1024 nt
    buffer_load_dwordx4 v[104:107], v5, s[44:47], 0 offen offset:2048 nt
    buffer_load_dwordx4 v[108:111], v5, s[44:47], 0 offen offset:3072 nt
    s_add_u32 s69, s67, 10
    s_and_b32 s69, s69, 1023
    s_lshl_b32 s69, s69, 12
    v_add_u32 v5, s69, v1
    s_waitcnt vmcnt(0)
    buffer_load_dwordx4 v[112:115], v5, s[44:47], 0 offen offset:0 nt
    buffer_load_dwordx4 v[116:119], v5, s[44:47], 0 offen offset:1024 nt
    buffer_load_dwordx4 v[120:123], v5, s[44:47], 0 offen offset:2048 nt
    buffer_load_dwordx4 v[124:127], v5, s[44:47], 0 offen offset:3072 nt
    s_add_u32 s69, s67, 15
    s_and_b32 s69, s69, 1023
    s_lshl_b32 s69, s69, 12
    v_add_u32 v5, s69, v1
    s_waitcnt vmcnt(0)
    buffer_load_dwordx4 v[128:131], v5, s[44:47], 0 offen offset:0 nt
    buffer_load_dwordx4 v[132:135], v5, s[44:47], 0 offen offset:1024 nt
    buffer_load_dwordx4 v[136:139], v5, s[44:47], 0 offen offset:2048 nt
    buffer_load_dwordx4 v[140:143], v5, s[44:47], 0 offen offset:3072 nt
    s_add_u32 s69, s67, 20
    s_and_b32 s69, s69, 1023
    s_lshl_b32 s69, s69, 12
    v_add_u32 v5, s69, v1
    s_waitcnt vmcnt(0)
    buffer_load_dwordx4 v[144:147], v5, s[44:47], 0 offen offset:0 nt
    buffer_load_dwordx4 v[148:151], v5, s[44:47], 0 offen offset:1024 nt
    buffer_load_dwordx4 v[152:155], v5, s[44:47], 0 offen offset:2048 nt
    buffer_load_dwordx4 v[156:159], v5, s[44:47], 0 offen offset:3072 nt
    s_add_u32 s69, s67, 25
    s_and_b32 s69, s69, 1023
    s_lshl_b32 s69, s69, 12
    v_add_u32 v5, s69, v1
    s_waitcnt vmcnt(0)
    buffer_load_dwordx4 v[160:163], v5, s[44:47], 0 offen offset:0 nt
    buffer_load_dwordx4 v[164:167], v5, s[44:47], 0 offen offset:1024 nt
    buffer_load_dwordx4 v[168:171], v5, s[44:47], 0 offen offset:2048 nt
    buffer_load_dwordx4 v[172:175], v5, s[44:47], 0 offen offset:3072 nt
    s_add_u32 s69, s67, 30
    s_and_b32 s69, s69, 1023
    s_lshl_b32 s69, s69, 12
    v_add_u32 v5, s69, v1
    s_waitcnt vmcnt(0)
    buffer_load_dwordx4 v[176:179], v5, s[44:47], 0 offen offset:0 nt
    buffer_load_dwordx4 v[180:183], v5, s[44:47], 0 offen offset:1024 nt
    buffer_load_dwordx4 v[184:187], v5, s[44:47], 0 offen offset:2048 nt
    buffer_load_dwordx4 v[188:191], v5, s[44:47], 0 offen offset:3072 nt
    s_add_u32 s69, s67, 35
    s_and_b32 s69, s69, 1023
    s_lshl_b32 s69, s69, 12
    v_add_u32 v5, s69, v1
    s_waitcnt vmcnt(0)
    buffer_load_dwordx4 v[192:195], v5, s[44:47], 0 offen offset:0 nt
    buffer_load_dwordx4 v[196:199], v5, s[44:47], 0 offen offset:1024 nt
    buffer_load_dwordx4 v[200:203], v5, s[44:47], 0 offen offset:2048 nt
    buffer_load_dwordx4 v[204:207], v5, s[44:47], 0 offen offset:3072 nt
    s_add_u32 s69, s67, 40
    s_and_b32 s69, s69, 1023
    s_lshl_b32 s69, s69, 12
    v_add_u32 v5, s69, v1
    s_waitcnt vmcnt(0)
    buffer_load_dwordx4 v[208:211], v5, s[44:47], 0 offen offset:0 nt
    buffer_load_dwordx4 v[212:215], v5, s[44:47], 0 offen offset:1024 nt
    buffer_load_dwordx4 v[216:219], v5, s[44:47], 0 offen offset:2048 nt
    buffer_load_dwordx4 v[220:223], v5, s[44:47], 0 offen offset:3072 nt
    s_add_u32 s69, s67, 45
    s_and_b32 s69, s69, 1023
    s_lshl_b32 s69, s69, 12
    v_add_u32 v5, s69, v1
    s_waitcnt vmcnt(0)
    buffer_load_dwordx4 v[224:227], v5, s[44:47], 0 offen offset:0 nt
    buffer_load_dwordx4 v[228:231], v5, s[44:47], 0 offen offset:1024 nt
    buffer_load_dwordx4 v[232:235], v5, s[44:47], 0 offen offset:2048 nt
    buffer_load_dwordx4 v[236:239], v5, s[44:47], 0 offen offset:3072 nt
    s_mov_b32 s64, 0x400000
L_lw_3:
    ds_read_b32 v11, v2 offset:12
    s_sub_u32 s64, s64, 1
    s_cmp_eq_u32 s64, 0
    s_cbranch_scc1 L_lwd_4
    s_waitcnt lgkmcnt(0)
    v_cmp_gt_u32 vcc, 1, v11
    s_cbranch_vccnz L_lw_3
L_lwd_4:
    ds_read_b32 v30, v2 offset:32
    v_and_b32 v8, 4, v9
    v_lshlrev_b32 v8, 2, v8
    v_sub_u32 v8, 16, v8
    s_lshl_b32 s14, s32, 13
    s_add_u32 s14, s14, 110848
    s_add_u32 s14, s14, s30
    s_addc_u32 s15, s31, 0
    ds_read_b32 v48, v7 offset:12288
    ds_read_b32 v49, v7 offset:12608
    ds_read_b32 v50, v7 offset:12928
    ds_read_b32 v51, v7 offset:13248
    ds_read_b32 v52, v7 offset:13568
    ds_read_b32 v53, v7 offset:13888
    ds_read_b32 v54, v7 offset:14208
    ds_read_b32 v55, v7 offset:14528
    ds_read_b32 v56, v7 offset:14848
    s_waitcnt lgkmcnt(2)
    ds_read_b32 v57, v7 offset:15168
    ds_read_b32 v58, v7 offset:15488
    ds_read_b32 v59, v7 offset:15808
    ds_read_b32 v24, v7 offset:16128
    ds_read_b32 v25, v7 offset:16448
    ds_read_b32 v26, v7 offset:16768
    ds_read_b32 v27, v7 offset:17088
    s_waitcnt lgkmcnt(0)
    s_add_u32 s69, s67, 50
    s_and_b32 s69, s69, 1023
    s_lshl_b32 s69, s69, 12
    v_add_u32 v5, s69, v1
    s_waitcnt vmcnt(0)
    buffer_load_dwordx4 v[64:67], v5, s[44:47], 0 offen offset:0 nt
    buffer_load_dwordx4 v[68:71], v5, s[44:47], 0 offen offset:1024 nt
    buffer_load_dwordx4 v[72:75], v5, s[44:47], 0 offen offset:2048 nt
    buffer_load_dwordx4 v[76:79], v5, s[44:47], 0 offen offset:3072 nt
    v_and_b32_dpp v32, v48, v16 row_newbcast:0 row_mask:0xf bank_mask:0xf
    v_and_b32_dpp v33, v48, v17 row_newbcast:0 row_mask:0xf bank_mask:0xf
    v_and_b32_dpp v34, v48, v18 row_newbcast:0 row_mask:0xf bank_mask:0xf
    v_and_b32_dpp v35, v48, v19 row_newbcast:0 row_mask:0xf bank_mask:0xf
    v_and_b32_dpp v36, v48, v16 row_newbcast:8 row_mask:0xf bank_mask:0xf
    v_and_b32_dpp v37, v48, v17 row_newbcast:8 row_mask:0xf bank_mask:0xf
    v_and_b32_dpp v38, v48, v18 row_newbcast:8 row_mask:0xf bank_mask:0xf
    v_and_b32_dpp v39, v48, v19 row_newbcast:8 row_mask:0xf bank_mask:0xf
    v_and_b32_dpp v40, v48, v16 row_newbcast:4 row_mask:0xf bank_mask:0xf
    v_and_b32_dpp v41, v48, v17 row_newbcast:4 row_mask:0xf bank_mask:0xf
    v_and_b32_dpp v42, v48, v18 row_newbcast:4 row_mask:0xf bank_mask:0xf
    v_and_b32_dpp v43, v48, v19 row_newbcast:4 row_mask:0xf bank_mask:0xf
    v_and_b32_dpp v44, v48, v16 row_newbcast:12 row_mask:0xf bank_mask:0xf
    v_and_b32_dpp v45, v48, v17 row_newbcast:12 row_mask:0xf bank_mask:0xf
    v_and_b32_dpp v46, v48, v18 row_newbcast:12 row_mask:0xf bank_mask:0xf
    v_and_b32_dpp v47, v48, v19 row_newbcast:12 row_mask:0xf bank_mask:0xf
    v_mfma_f32_16x16x32_bf16 v[20:23], v[32:35], v[80:83], v[20:23]
    v_mfma_f32_16x16x32_bf16 v[20:23], v[36:39], v[84:87], v[20:23]
    v_mfma_f32_16x16x32_bf16 v[20:23], v[40:43], v[88:91], v[20:23]
    v_mfma_f32_16x16x32_bf16 v[20:23], v[44:47], v[92:95], v[20:23]
    v_and_b32_dpp v32, v49, v16 row_newbcast:0 row_mask:0xf bank_mask:0xf
    v_and_b32_dpp v33, v49, v17 row_newbcast:0 row_mask:0xf bank_mask:0xf
    v_and_b32_dpp v34, v49, v18 row_newbcast:0 row_mask:0xf bank_mask:0xf
    v_and_b32_dpp v35, v49, v19 row_newbcast:0 row_mask:0xf bank_mask:0xf
    v_and_b32_dpp v36, v49, v16 row_newbcast:8 row_mask:0xf bank_mask:0xf
    v_and_b32_dpp v37, v49, v17 row_newbcast:8 row_mask:0xf bank_mask:0xf
    v_and_b32_dpp v38, v49, v18 row_newbcast:8 row_mask:0xf bank_mask:0xf
    v_and_b32_dpp v39, v49, v19 row_newbcast:8 row_mask:0xf bank_mask:0xf
    v_and_b32_dpp v40, v49, v16 row_newbcast:4 row_mask:0xf bank_mask:0xf
    v_and_b32_dpp v41, v49, v17 row_newbcast:4 row_mask:0xf bank_mask:0xf
    v_and_b32_dpp v42, v49, v18 row_newbcast:4 row_mask:0xf bank_mask:0xf
    v_and_b32_dpp v43, v49, v19 row_newbcast:4 row_mask:0xf bank_mask:0xf
    v_and_b32_dpp v44, v49, v16 row_newbcast:12 row_mask:0xf bank_mask:0xf
    v_and_b32_dpp v45, v49, v17 row_newbcast:12 row_mask:0xf bank_mask:0xf
    v_and_b32_dpp v46, v49, v18 row_newbcast:12 row_mask:0xf bank_mask:0xf
    v_and_b32_dpp v47, v49, v19 row_newbcast:12 row_mask:0xf bank_mask:0xf
    v_mfma_f32_16x16x32_bf16 v[20:23], v[32:35], v[96:99], v[20:23]
    v_mfma_f32_16x16x32_bf16 v[20:23], v[36:39], v[100:103], v[20:23]
    v_mfma_f32_16x16x32_bf16 v[20:23], v[40:43], v[104:107], v[20:23]
    v_mfma_f32_16x16x32_bf16 v[20:23], v[44:47], v[108:111], v[20:23]
    s_add_u32 s69, s67, 55
    s_and_b32 s69, s69, 1023
    s_lshl_b32 s69, s69, 12
    v_add_u32 v5, s69, v1
    s_waitcnt vmcnt(0)
    buffer_load_dwordx4 v[240:243], v5, s[44:47], 0 offen offset:0 nt
    buffer_load_dwordx4 v[244:247], v5, s[44:47], 0 offen offset:1024 nt
    buffer_load_dwordx4 v[248:251], v5, s[44:47], 0 offen offset:2048 nt
    buffer_load_dwordx4 v[252:255], v5, s[44:47], 0 offen offset:3072 nt
    v_and_b32_dpp v32, v58, v16 row_newbcast:0 row_mask:0xf bank_mask:0xf
    v_and_b32_dpp v33, v58, v17 row_newbcast:0 row_mask:0xf bank_mask:0xf
    v_and_b32_dpp v34, v58, v18 row_newbcast:0 row_mask:0xf bank_mask:0xf
    v_and_b32_dpp v35, v58, v19 row_newbcast:0 row_mask:0xf bank_mask:0xf
    v_and_b32_dpp v36, v58, v16 row_newbcast:8 row_mask:0xf bank_mask:0xf
    v_and_b32_dpp v37, v58, v17 row_newbcast:8 row_mask:0xf bank_mask:0xf
    v_and_b32_dpp v38, v58, v18 row_newbcast:8 row_mask:0xf bank_mask:0xf
    v_and_b32_dpp v39, v58, v19 row_newbcast:8 row_mask:0xf bank_mask:0xf
    v_and_b32_dpp v40, v58, v16 row_newbcast:4 row_mask:0xf bank_mask:0xf
    v_and_b32_dpp v41, v58, v17 row_newbcast:4 row_mask:0xf bank_mask:0xf
    v_and_b32_dpp v42, v58, v18 row_newbcast:4 row_mask:0xf bank_mask:0xf
    v_and_b32_dpp v43, v58, v19 row_newbcast:4 row_mask:0xf bank_mask:0xf
    v_and_b32_dpp v44, v58, v16 row_newbcast:12 row_mask:0xf bank_mask:0xf
    v_and_b32_dpp v45, v58, v17 row_newbcast:12 row_mask:0xf bank_mask:0xf
    v_and_b32_dpp v46, v58, v18 row_newbcast:12 row_mask:0xf bank_mask:0xf
    v_and_b32_dpp v47, v58, v19 row_newbcast:12 row_mask:0xf bank_mask:0xf
    v_mfma_f32_16x16x32_bf16 v[20:23], v[32:35], v[64:67], v[20:23]
    v_mfma_f32_16x16x32_bf16 v[20:23], v[36:39], v[68:71], v[20:23]
    v_mfma_f32_16x16x32_bf16 v[20:23], v[40:43], v[72:75], v[20:23]
    v_mfma_f32_16x16x32_bf16 v[20:23], v[44:47], v[76:79], v[20:23]
    v_and_b32_dpp v32, v50, v16 row_newbcast:0 row_mask:0xf bank_mask:0xf
    v_and_b32_dpp v33, v50, v17 row_newbcast:0 row_mask:0xf bank_mask:0xf
    v_and_b32_dpp v34, v50, v18 row_newbcast:0 row_mask:0xf bank_mask:0xf
    v_and_b32_dpp v35, v50, v19 row_newbcast:0 row_mask:0xf bank_mask:0xf
    v_and_b32_dpp v36, v50, v16 row_newbcast:8 row_mask:0xf bank_mask:0xf
    v_and_b32_dpp v37, v50, v17 row_newbcast:8 row_mask:0xf bank_mask:0xf
    v_and_b32_dpp v38, v50, v18 row_newbcast:8 row_mask:0xf bank_mask:0xf
    v_and_b32_dpp v39, v50, v19 row_newbcast:8 row_mask:0xf bank_mask:0xf
    v_and_b32_dpp v40, v50, v16 row_newbcast:4 row_mask:0xf bank_mask:0xf
    v_and_b32_dpp v41, v50, v17 row_newbcast:4 row_mask:0xf bank_mask:0xf
    v_and_b32_dpp v42, v50, v18 row_newbcast:4 row_mask:0xf bank_mask:0xf
    v_and_b32_dpp v43, v50, v19 row_newbcast:4 row_mask:0xf bank_mask:0xf
    v_and_b32_dpp v44, v50, v16 row_newbcast:12 row_mask:0xf bank_mask:0xf
    v_and_b32_dpp v45, v50, v17 row_newbcast:12 row_mask:0xf bank_mask:0xf
    v_and_b32_dpp v46, v50, v18 row_newbcast:12 row_mask:0xf bank_mask:0xf
    v_and_b32_dpp v47, v50, v19 row_newbcast:12 row_mask:0xf bank_mask:0xf
    v_mfma_f32_16x16x32_bf16 v[20:23], v[32:35], v[112:115], v[20:23]
    v_mfma_f32_16x16x32_bf16 v[20:23], v[36:39], v[116:119], v[20:23]
    v_mfma_f32_16x16x32_bf16 v[20:23], v[40:43], v[120:123], v[20:23]
    v_mfma_f32_16x16x32_bf16 v[20:23], v[44:47], v[124:127], v[20:23]
    v_and_b32_dpp v32, v51, v16 row_newbcast:0 row_mask:0xf bank_mask:0xf
    v_and_b32_dpp v33, v51, v17 row_newbcast:0 row_mask:0xf bank_mask:0xf
    v_and_b32_dpp v34, v51, v18 row_newbcast:0 row_mask:0xf bank_mask:0xf
    v_and_b32_dpp v35, v51, v19 row_newbcast:0 row_mask:0xf bank_mask:0xf
    v_and_b32_dpp v36, v51, v16 row_newbcast:8 row_mask:0xf bank_mask:0xf
    v_and_b32_dpp v37, v51, v17 row_newbcast:8 row_mask:0xf bank_mask:0xf
    v_and_b32_dpp v38, v51, v18 row_newbcast:8 row_mask:0xf bank_mask:0xf
    v_and_b32_dpp v39, v51, v19 row_newbcast:8 row_mask:0xf bank_mask:0xf
    v_and_b32_dpp v40, v51, v16 row_newbcast:4 row_mask:0xf bank_mask:0xf
    v_and_b32_dpp v41, v51, v17 row_newbcast:4 row_mask:0xf bank_mask:0xf
    v_and_b32_dpp v42, v51, v18 row_newbcast:4 row_mask:0xf bank_mask:0xf
    v_and_b32_dpp v43, v51, v19 row_newbcast:4 row_mask:0xf bank_mask:0xf
    v_and_b32_dpp v44, v51, v16 row_newbcast:12 row_mask:0xf bank_mask:0xf
    v_and_b32_dpp v45, v51, v17 row_newbcast:12 row_mask:0xf bank_mask:0xf
    v_and_b32_dpp v46, v51, v18 row_newbcast:12 row_mask:0xf bank_mask:0xf
    v_and_b32_dpp v47, v51, v19 row_newbcast:12 row_mask:0xf bank_mask:0xf
    v_mfma_f32_16x16x32_bf16 v[20:23], v[32:35], v[128:131], v[20:23]
    v_mfma_f32_16x16x32_bf16 v[20:23], v[36:39], v[132:135], v[20:23]
    v_mfma_f32_16x16x32_bf16 v[20:23], v[40:43], v[136:139], v[20:23]
    v_mfma_f32_16x16x32_bf16 v[20:23], v[44:47], v[140:143], v[20:23]
    s_add_u32 s69, s67, 60
    s_and_b32 s69, s69, 1023
    s_lshl_b32 s69, s69, 12
    v_add_u32 v5, s69, v1
    s_waitcnt vmcnt(0)
    buffer_load_dwordx4 v[64:67], v5, s[44:47], 0 offen offset:0 nt
    buffer_load_dwordx4 v[68:71], v5, s[44:47], 0 offen offset:1024 nt
    buffer_load_dwordx4 v[72:75], v5, s[44:47], 0 offen offset:2048 nt
    buffer_load_dwordx4 v[76:79], v5, s[44:47], 0 offen offset:3072 nt
    v_and_b32_dpp v32, v59, v16 row_newbcast:0 row_mask:0xf bank_mask:0xf
    v_and_b32_dpp v33, v59, v17 row_newbcast:0 row_mask:0xf bank_mask:0xf
    v_and_b32_dpp v34, v59, v18 row_newbcast:0 row_mask:0xf bank_mask:0xf
    v_and_b32_dpp v35, v59, v19 row_newbcast:0 row_mask:0xf bank_mask:0xf
    v_and_b32_dpp v36, v59, v16 row_newbcast:8 row_mask:0xf bank_mask:0xf
    v_and_b32_dpp v37, v59, v17 row_newbcast:8 row_mask:0xf bank_mask:0xf
    v_and_b32_dpp v38, v59, v18 row_newbcast:8 row_mask:0xf bank_mask:0xf
    v_and_b32_dpp v39, v59, v19 row_newbcast:8 row_mask:0xf bank_mask:0xf
    v_and_b32_dpp v40, v59, v16 row_newbcast:4 row_mask:0xf bank_mask:0xf
    v_and_b32_dpp v41, v59, v17 row_newbcast:4 row_mask:0xf bank_mask:0xf
    v_and_b32_dpp v42, v59, v18 row_newbcast:4 row_mask:0xf bank_mask:0xf
    v_and_b32_dpp v43, v59, v19 row_newbcast:4 row_mask:0xf bank_mask:0xf
    v_and_b32_dpp v44, v59, v16 row_newbcast:12 row_mask:0xf bank_mask:0xf
    v_and_b32_dpp v45, v59, v17 row_newbcast:12 row_mask:0xf bank_mask:0xf
    v_and_b32_dpp v46, v59, v18 row_newbcast:12 row_mask:0xf bank_mask:0xf
    v_and_b32_dpp v47, v59, v19 row_newbcast:12 row_mask:0xf bank_mask:0xf
    v_mfma_f32_16x16x32_bf16 v[20:23], v[32:35], v[240:243], v[20:23]
    v_mfma_f32_16x16x32_bf16 v[20:23], v[36:39], v[244:247], v[20:23]
    v_mfma_f32_16x16x32_bf16 v[20:23], v[40:43], v[248:251], v[20:23]
    v_mfma_f32_16x16x32_bf16 v[20:23], v[44:47], v[252:255], v[20:23]
    v_and_b32_dpp v32, v52, v16 row_newbcast:0 row_mask:0xf bank_mask:0xf
    v_and_b32_dpp v33, v52, v17 row_newbcast:0 row_mask:0xf bank_mask:0xf
    v_and_b32_dpp v34, v52, v18 row_newbcast:0 row_mask:0xf bank_mask:0xf
    v_and_b32_dpp v35, v52, v19 row_newbcast:0 row_mask:0xf bank_mask:0xf
    v_and_b32_dpp v36, v52, v16 row_newbcast:8 row_mask:0xf bank_mask:0xf
    v_and_b32_dpp v37, v52, v17 row_newbcast:8 row_mask:0xf bank_mask:0xf
    v_and_b32_dpp v38, v52, v18 row_newbcast:8 row_mask:0xf bank_mask:0xf
    v_and_b32_dpp v39, v52, v19 row_newbcast:8 row_mask:0xf bank_mask:0xf
    v_and_b32_dpp v40, v52, v16 row_newbcast:4 row_mask:0xf bank_mask:0xf
    v_and_b32_dpp v41, v52, v17 row_newbcast:4 row_mask:0xf bank_mask:0xf
    v_and_b32_dpp v42, v52, v18 row_newbcast:4 row_mask:0xf bank_mask:0xf
    v_and_b32_dpp v43, v52, v19 row_newbcast:4 row_mask:0xf bank_mask:0xf
    v_and_b32_dpp v44, v52, v16 row_newbcast:12 row_mask:0xf bank_mask:0xf
    v_and_b32_dpp v45, v52, v17 row_newbcast:12 row_mask:0xf bank_mask:0xf
    v_and_b32_dpp v46, v52, v18 row_newbcast:12 row_mask:0xf bank_mask:0xf
    v_and_b32_dpp v47, v52, v19 row_newbcast:12 row_mask:0xf bank_mask:0xf
    v_mfma_f32_16x16x32_bf16 v[20:23], v[32:35], v[144:147], v[20:23]
    v_mfma_f32_16x16x32_bf16 v[20:23], v[36:39], v[148:151], v[20:23]
    v_mfma_f32_16x16x32_bf16 v[20:23], v[40:43], v[152:155], v[20:23]
    v_mfma_f32_16x16x32_bf16 v[20:23], v[44:47], v[156:159], v[20:23]
    v_and_b32_dpp v32, v53, v16 row_newbcast:0 row_mask:0xf bank_mask:0xf
    v_and_b32_dpp v33, v53, v17 row_newbcast:0 row_mask:0xf bank_mask:0xf
    v_and_b32_dpp v34, v53, v18 row_newbcast:0 row_mask:0xf bank_mask:0xf
    v_and_b32_dpp v35, v53, v19 row_newbcast:0 row_mask:0xf bank_mask:0xf
    v_and_b32_dpp v36, v53, v16 row_newbcast:8 row_mask:0xf bank_mask:0xf
    v_and_b32_dpp v37, v53, v17 row_newbcast:8 row_mask:0xf bank_mask:0xf
    v_and_b32_dpp v38, v53, v18 row_newbcast:8 row_mask:0xf bank_mask:0xf
    v_and_b32_dpp v39, v53, v19 row_newbcast:8 row_mask:0xf bank_mask:0xf
    v_and_b32_dpp v40, v53, v16 row_newbcast:4 row_mask:0xf bank_mask:0xf
    v_and_b32_dpp v41, v53, v17 row_newbcast:4 row_mask:0xf bank_mask:0xf
    v_and_b32_dpp v42, v53, v18 row_newbcast:4 row_mask:0xf bank_mask:0xf
    v_and_b32_dpp v43, v53, v19 row_newbcast:4 row_mask:0xf bank_mask:0xf
    v_and_b32_dpp v44, v53, v16 row_newbcast:12 row_mask:0xf bank_mask:0xf
    v_and_b32_dpp v45, v53, v17 row_newbcast:12 row_mask:0xf bank_mask:0xf
    v_and_b32_dpp v46, v53, v18 row_newbcast:12 row_mask:0xf bank_mask:0xf
    v_and_b32_dpp v47, v53, v19 row_newbcast:12 row_mask:0xf bank_mask:0xf
    v_mfma_f32_16x16x32_bf16 v[20:23], v[32:35], v[160:163], v[20:23]
    v_mfma_f32_16x16x32_bf16 v[20:23], v[36:39], v[164:167], v[20:23]
    v_mfma_f32_16x16x32_bf16 v[20:23], v[40:43], v[168:171], v[20:23]
    v_mfma_f32_16x16x32_bf16 v[20:23], v[44:47], v[172:175], v[20:23]
    s_add_u32 s69, s67, 65
    s_and_b32 s69, s69, 1023
    s_lshl_b32 s69, s69, 12
    v_add_u32 v5, s69, v1
    s_waitcnt vmcnt(0)
    buffer_load_dwordx4 v[240:243], v5, s[44:47], 0 offen offset:0 nt
    buffer_load_dwordx4 v[244:247], v5, s[44:47], 0 offen offset:1024 nt
    buffer_load_dwordx4 v[248:251], v5, s[44:47], 0 offen offset:2048 nt
    buffer_load_dwordx4 v[252:255], v5, s[44:47], 0 offen offset:3072 nt
    v_and_b32_dpp v32, v24, v16 row_newbcast:0 row_mask:0xf bank_mask:0xf
    v_and_b32_dpp v33, v24, v17 row_newbcast:0 row_mask:0xf bank_mask:0xf
    v_and_b32_dpp v34, v24, v18 row_newbcast:0 row_mask:0xf bank_mask:0xf
    v_and_b32_dpp v35, v24, v19 row_newbcast:0 row_mask:0xf bank_mask:0xf
    v_and_b32_dpp v36, v24, v16 row_newbcast:8 row_mask:0xf bank_mask:0xf
    v_and_b32_dpp v37, v24, v17 row_newbcast:8 row_mask:0xf bank_mask:0xf
    v_and_b32_dpp v38, v24, v18 row_newbcast:8 row_mask:0xf bank_mask:0xf
    v_and_b32_dpp v39, v24, v19 row_newbcast:8 row_mask:0xf bank_mask:0xf
    v_and_b32_dpp v40, v24, v16 row_newbcast:4 row_mask:0xf bank_mask:0xf
    v_and_b32_dpp v41, v24, v17 row_newbcast:4 row_mask:0xf bank_mask:0xf
    v_and_b32_dpp v42, v24, v18 row_newbcast:4 row_mask:0xf bank_mask:0xf
    v_and_b32_dpp v43, v24, v19 row_newbcast:4 row_mask:0xf bank_mask:0xf
    v_and_b32_dpp v44, v24, v16 row_newbcast:12 row_mask:0xf bank_mask:0xf
    v_and_b32_dpp v45, v24, v17 row_newbcast:12 row_mask:0xf bank_mask:0xf
    v_and_b32_dpp v46, v24, v18 row_newbcast:12 row_mask:0xf bank_mask:0xf
    v_and_b32_dpp v47, v24, v19 row_newbcast:12 row_mask:0xf bank_mask:0xf
    v_mfma_f32_16x16x32_bf16 v[20:23], v[32:35], v[64:67], v[20:23]
    v_mfma_f32_16x16x32_bf16 v[20:23], v[36:39], v[68:71], v[20:23]
    v_mfma_f32_16x16x32_bf16 v[20:23], v[40:43], v[72:75], v[20:23]
    v_mfma_f32_16x16x32_bf16 v[20:23], v[44:47], v[76:79], v[20:23]
    v_and_b32_dpp v32, v54, v16 row_newbcast:0 row_mask:0xf bank_mask:0xf
    v_and_b32_dpp v33, v54, v17 row_newbcast:0 row_mask:0xf bank_mask:0xf
    v_and_b32_dpp v34, v54, v18 row_newbcast:0 row_mask:0xf bank_mask:0xf
    v_and_b32_dpp v35, v54, v19 row_newbcast:0 row_mask:0xf bank_mask:0xf
    v_and_b32_dpp v36, v54, v16 row_newbcast:8 row_mask:0xf bank_mask:0xf
    v_and_b32_dpp v37, v54, v17 row_newbcast:8 row_mask:0xf bank_mask:0xf
    v_and_b32_dpp v38, v54, v18 row_newbcast:8 row_mask:0xf bank_mask:0xf
    v_and_b32_dpp v39, v54, v19 row_newbcast:8 row_mask:0xf bank_mask:0xf
    v_and_b32_dpp v40, v54, v16 row_newbcast:4 row_mask:0xf bank_mask:0xf
    v_and_b32_dpp v41, v54, v17 row_newbcast:4 row_mask:0xf bank_mask:0xf
    v_and_b32_dpp v42, v54, v18 row_newbcast:4 row_mask:0xf bank_mask:0xf
    v_and_b32_dpp v43, v54, v19 row_newbcast:4 row_mask:0xf bank_mask:0xf
    v_and_b32_dpp v44, v54, v16 row_newbcast:12 row_mask:0xf bank_mask:0xf
    v_and_b32_dpp v45, v54, v17 row_newbcast:12 row_mask:0xf bank_mask:0xf
    v_and_b32_dpp v46, v54, v18 row_newbcast:12 row_mask:0xf bank_mask:0xf
    v_and_b32_dpp v47, v54, v19 row_newbcast:12 row_mask:0xf bank_mask:0xf
    v_mfma_f32_16x16x32_bf16 v[20:23], v[32:35], v[176:179], v[20:23]
    v_mfma_f32_16x16x32_bf16 v[20:23], v[36:39], v[180:183], v[20:23]
    v_mfma_f32_16x16x32_bf16 v[20:23], v[40:43], v[184:187], v[20:23]
    v_mfma_f32_16x16x32_bf16 v[20:23], v[44:47], v[188:191], v[20:23]
    v_and_b32_dpp v32, v55, v16 row_newbcast:0 row_mask:0xf bank_mask:0xf
    v_and_b32_dpp v33, v55, v17 row_newbcast:0 row_mask:0xf bank_mask:0xf
    v_and_b32_dpp v34, v55, v18 row_newbcast:0 row_mask:0xf bank_mask:0xf
    v_and_b32_dpp v35, v55, v19 row_newbcast:0 row_mask:0xf bank_mask:0xf
    v_and_b32_dpp v36, v55, v16 row_newbcast:8 row_mask:0xf bank_mask:0xf
    v_and_b32_dpp v37, v55, v17 row_newbcast:8 row_mask:0xf bank_mask:0xf
    v_and_b32_dpp v38, v55, v18 row_newbcast:8 row_mask:0xf bank_mask:0xf
    v_and_b32_dpp v39, v55, v19 row_newbcast:8 row_mask:0xf bank_mask:0xf
    v_and_b32_dpp v40, v55, v16 row_newbcast:4 row_mask:0xf bank_mask:0xf
    v_and_b32_dpp v41, v55, v17 row_newbcast:4 row_mask:0xf bank_mask:0xf
    v_and_b32_dpp v42, v55, v18 row_newbcast:4 row_mask:0xf bank_mask:0xf
    v_and_b32_dpp v43, v55, v19 row_newbcast:4 row_mask:0xf bank_mask:0xf
    v_and_b32_dpp v44, v55, v16 row_newbcast:12 row_mask:0xf bank_mask:0xf
    v_and_b32_dpp v45, v55, v17 row_newbcast:12 row_mask:0xf bank_mask:0xf
    v_and_b32_dpp v46, v55, v18 row_newbcast:12 row_mask:0xf bank_mask:0xf
    v_and_b32_dpp v47, v55, v19 row_newbcast:12 row_mask:0xf bank_mask:0xf
    v_mfma_f32_16x16x32_bf16 v[20:23], v[32:35], v[192:195], v[20:23]
    v_mfma_f32_16x16x32_bf16 v[20:23], v[36:39], v[196:199], v[20:23]
    v_mfma_f32_16x16x32_bf16 v[20:23], v[40:43], v[200:203], v[20:23]
    v_mfma_f32_16x16x32_bf16 v[20:23], v[44:47], v[204:207], v[20:23]
    s_add_u32 s69, s67, 70
    s_and_b32 s69, s69, 1023
    s_lshl_b32 s69, s69, 12
    v_add_u32 v5, s69, v1
    s_waitcnt vmcnt(0)
    buffer_load_dwordx4 v[64:67], v5, s[44:47], 0 offen offset:0 nt
    buffer_load_dwordx4 v[68:71], v5, s[44:47], 0 offen offset:1024 nt
    buffer_load_dwordx4 v[72:75], v5, s[44:47], 0 offen offset:2048 nt
    buffer_load_dwordx4 v[76:79], v5, s[44:47], 0 offen offset:3072 nt
    v_and_b32_dpp v32, v25, v16 row_newbcast:0 row_mask:0xf bank_mask:0xf
    v_and_b32_dpp v33, v25, v17 row_newbcast:0 row_mask:0xf bank_mask:0xf
    v_and_b32_dpp v34, v25, v18 row_newbcast:0 row_mask:0xf bank_mask:0xf
    v_and_b32_dpp v35, v25, v19 row_newbcast:0 row_mask:0xf bank_mask:0xf
    v_and_b32_dpp v36, v25, v16 row_newbcast:8 row_mask:0xf bank_mask:0xf
    v_and_b32_dpp v37, v25, v17 row_newbcast:8 row_mask:0xf bank_mask:0xf
    v_and_b32_dpp v38, v25, v18 row_newbcast:8 row_mask:0xf bank_mask:0xf
    v_and_b32_dpp v39, v25, v19 row_newbcast:8 row_mask:0xf bank_mask:0xf
    v_and_b32_dpp v40, v25, v16 row_newbcast:4 row_mask:0xf bank_mask:0xf
    v_and_b32_dpp v41, v25, v17 row_newbcast:4 row_mask:0xf bank_mask:0xf
    v_and_b32_dpp v42, v25, v18 row_newbcast:4 row_mask:0xf bank_mask:0xf
    v_and_b32_dpp v43, v25, v19 row_newbcast:4 row_mask:0xf bank_mask:0xf
    v_and_b32_dpp v44, v25, v16 row_newbcast:12 row_mask:0xf bank_mask:0xf
    v_and_b32_dpp v45, v25, v17 row_newbcast:12 row_mask:0xf bank_mask:0xf
    v_and_b32_dpp v46, v25, v18 row_newbcast:12 row_mask:0xf bank_mask:0xf
    v_and_b32_dpp v47, v25, v19 row_newbcast:12 row_mask:0xf bank_mask:0xf
    v_mfma_f32_16x16x32_bf16 v[20:23], v[32:35], v[240:243], v[20:23]
    v_mfma_f32_16x16x32_bf16 v[20:23], v[36:39], v[244:247], v[20:23]
    v_mfma_f32_16x16x32_bf16 v[20:23], v[40:43], v[248:251], v[20:23]
    v_mfma_f32_16x16x32_bf16 v[20:23], v[44:47], v[252:255], v[20:23]
    v_and_b32_dpp v32, v56, v16 row_newbcast:0 row_mask:0xf bank_mask:0xf
    v_and_b32_dpp v33, v56, v17 row_newbcast:0 row_mask:0xf bank_mask:0xf
    v_and_b32_dpp v34, v56, v18 row_newbcast:0 row_mask:0xf bank_mask:0xf
    v_and_b32_dpp v35, v56, v19 row_newbcast:0 row_mask:0xf bank_mask:0xf
    v_and_b32_dpp v36, v56, v16 row_newbcast:8 row_mask:0xf bank_mask:0xf
    v_and_b32_dpp v37, v56, v17 row_newbcast:8 row_mask:0xf bank_mask:0xf
    v_and_b32_dpp v38, v56, v18 row_newbcast:8 row_mask:0xf bank_mask:0xf
    v_and_b32_dpp v39, v56, v19 row_newbcast:8 row_mask:0xf bank_mask:0xf
    v_and_b32_dpp v40, v56, v16 row_newbcast:4 row_mask:0xf bank_mask:0xf
    v_and_b32_dpp v41, v56, v17 row_newbcast:4 row_mask:0xf bank_mask:0xf
    v_and_b32_dpp v42, v56, v18 row_newbcast:4 row_mask:0xf bank_mask:0xf
    v_and_b32_dpp v43, v56, v19 row_newbcast:4 row_mask:0xf bank_mask:0xf
    v_and_b32_dpp v44, v56, v16 row_newbcast:12 row_mask:0xf bank_mask:0xf
    v_and_b32_dpp v45, v56, v17 row_newbcast:12 row_mask:0xf bank_mask:0xf
    v_and_b32_dpp v46, v56, v18 row_newbcast:12 row_mask:0xf bank_mask:0xf
    v_and_b32_dpp v47, v56, v19 row_newbcast:12 row_mask:0xf bank_mask:0xf
    v_mfma_f32_16x16x32_bf16 v[20:23], v[32:35], v[208:211], v[20:23]
    v_mfma_f32_16x16x32_bf16 v[20:23], v[36:39], v[212:215], v[20:23]
    v_mfma_f32_16x16x32_bf16 v[20:23], v[40:43], v[216:219], v[20:23]
    v_mfma_f32_16x16x32_bf16 v[20:23], v[44:47], v[220:223], v[20:23]
    v_and_b32_dpp v32, v57, v16 row_newbcast:0 row_mask:0xf bank_mask:0xf
    v_and_b32_dpp v33, v57, v17 row_newbcast:0 row_mask:0xf bank_mask:0xf
    v_and_b32_dpp v34, v57, v18 row_newbcast:0 row_mask:0xf bank_mask:0xf
    v_and_b32_dpp v35, v57, v19 row_newbcast:0 row_mask:0xf bank_mask:0xf
    v_and_b32_dpp v36, v57, v16 row_newbcast:8 row_mask:0xf bank_mask:0xf
    v_and_b32_dpp v37, v57, v17 row_newbcast:8 row_mask:0xf bank_mask:0xf
    v_and_b32_dpp v38, v57, v18 row_newbcast:8 row_mask:0xf bank_mask:0xf
    v_and_b32_dpp v39, v57, v19 row_newbcast:8 row_mask:0xf bank_mask:0xf
    v_and_b32_dpp v40, v57, v16 row_newbcast:4 row_mask:0xf bank_mask:0xf
    v_and_b32_dpp v41, v57, v17 row_newbcast:4 row_mask:0xf bank_mask:0xf
    v_and_b32_dpp v42, v57, v18 row_newbcast:4 row_mask:0xf bank_mask:0xf
    v_and_b32_dpp v43, v57, v19 row_newbcast:4 row_mask:0xf bank_mask:0xf
    v_and_b32_dpp v44, v57, v16 row_newbcast:12 row_mask:0xf bank_mask:0xf
    v_and_b32_dpp v45, v57, v17 row_newbcast:12 row_mask:0xf bank_mask:0xf
    v_and_b32_dpp v46, v57, v18 row_newbcast:12 row_mask:0xf bank_mask:0xf
    v_and_b32_dpp v47, v57, v19 row_newbcast:12 row_mask:0xf bank_mask:0xf
    v_mfma_f32_16x16x32_bf16 v[20:23], v[32:35], v[224:227], v[20:23]
    v_mfma_f32_16x16x32_bf16 v[20:23], v[36:39], v[228:231], v[20:23]
    v_mfma_f32_16x16x32_bf16 v[20:23], v[40:43], v[232:235], v[20:23]
    v_mfma_f32_16x16x32_bf16 v[20:23], v[44:47], v[236:239], v[20:23]
    s_add_u32 s69, s67, 75
    s_and_b32 s69, s69, 1023
    s_lshl_b32 s69, s69, 12
    v_add_u32 v5, s69, v1
    s_waitcnt vmcnt(0)
    buffer_load_dwordx4 v[240:243], v5, s[44:47], 0 offen offset:0 nt
    buffer_load_dwordx4 v[244:247], v5, s[44:47], 0 offen offset:1024 nt
    buffer_load_dwordx4 v[248:251], v5, s[44:47], 0 offen offset:2048 nt
    buffer_load_dwordx4 v[252:255], v5, s[44:47], 0 offen offset:3072 nt
    s_mov_b64 exec, 1
    ds_add_rtn_u32 v4, v2, v3 offset:4
    s_mov_b64 exec, -1
    v_and_b32_dpp v32, v26, v16 row_newbcast:0 row_mask:0xf bank_mask:0xf
    v_and_b32_dpp v33, v26, v17 row_newbcast:0 row_mask:0xf bank_mask:0xf
    v_and_b32_dpp v34, v26, v18 row_newbcast:0 row_mask:0xf bank_mask:0xf
    v_and_b32_dpp v35, v26, v19 row_newbcast:0 row_mask:0xf bank_mask:0xf
    v_and_b32_dpp v36, v26, v16 row_newbcast:8 row_mask:0xf bank_mask:0xf
    v_and_b32_dpp v37, v26, v17 row_newbcast:8 row_mask:0xf bank_mask:0xf
    v_and_b32_dpp v38, v26, v18 row_newbcast:8 row_mask:0xf bank_mask:0xf
    v_and_b32_dpp v39, v26, v19 row_newbcast:8 row_mask:0xf bank_mask:0xf
    v_and_b32_dpp v40, v26, v16 row_newbcast:4 row_mask:0xf bank_mask:0xf
    v_and_b32_dpp v41, v26, v17 row_newbcast:4 row_mask:0xf bank_mask:0xf
    v_and_b32_dpp v42, v26, v18 row_newbcast:4 row_mask:0xf bank_mask:0xf
    v_and_b32_dpp v43, v26, v19 row_newbcast:4 row_mask:0xf bank_mask:0xf
    v_and_b32_dpp v44, v26, v16 row_newbcast:12 row_mask:0xf bank_mask:0xf
    v_and_b32_dpp v45, v26, v17 row_newbcast:12 row_mask:0xf bank_mask:0xf
    v_and_b32_dpp v46, v26, v18 row_newbcast:12 row_mask:0xf bank_mask:0xf
    v_and_b32_dpp v47, v26, v19 row_newbcast:12 row_mask:0xf bank_mask:0xf
    v_mfma_f32_16x16x32_bf16 v[20:23], v[32:35], v[64:67], v[20:23]
    v_mfma_f32_16x16x32_bf16 v[20:23], v[36:39], v[68:71], v[20:23]
    v_mfma_f32_16x16x32_bf16 v[20:23], v[40:43], v[72:75], v[20:23]
    v_mfma_f32_16x16x32_bf16 v[20:23], v[44:47], v[76:79], v[20:23]
    v_and_b32_dpp v32, v27, v16 row_newbcast:0 row_mask:0xf bank_mask:0xf
    v_and_b32_dpp v33, v27, v17 row_newbcast:0 row_mask:0xf bank_mask:0xf
    v_and_b32_dpp v34, v27, v18 row_newbcast:0 row_mask:0xf bank_mask:0xf
    v_and_b32_dpp v35, v27, v19 row_newbcast:0 row_mask:0xf bank_mask:0xf
    v_and_b32_dpp v36, v27, v16 row_newbcast:8 row_mask:0xf bank_mask:0xf
    v_and_b32_dpp v37, v27, v17 row_newbcast:8 row_mask:0xf bank_mask:0xf
    v_and_b32_dpp v38, v27, v18 row_newbcast:8 row_mask:0xf bank_mask:0xf
    v_and_b32_dpp v39, v27, v19 row_newbcast:8 row_mask:0xf bank_mask:0xf
    v_and_b32_dpp v40, v27, v16 row_newbcast:4 row_mask:0xf bank_mask:0xf
    v_and_b32_dpp v41, v27, v17 row_newbcast:4 row_mask:0xf bank_mask:0xf
    v_and_b32_dpp v42, v27, v18 row_newbcast:4 row_mask:0xf bank_mask:0xf
    v_and_b32_dpp v43, v27, v19 row_newbcast:4 row_mask:0xf bank_mask:0xf
    v_and_b32_dpp v44, v27, v16 row_newbcast:12 row_mask:0xf bank_mask:0xf
    v_and_b32_dpp v45, v27, v17 row_newbcast:12 row_mask:0xf bank_mask:0xf
    v_and_b32_dpp v46, v27, v18 row_newbcast:12 row_mask:0xf bank_mask:0xf
    v_and_b32_dpp v47, v27, v19 row_newbcast:12 row_mask:0xf bank_mask:0xf
L_v0:
    s_waitcnt lgkmcnt(0)
    v_readfirstlane_b32 s66, v4
    s_cmp_ge_u32 s66, 120
    s_cbranch_scc1 L_din0
    s_lshl_b32 s68, s66, 6
    v_add_u32 v31, s68, v6
    ds_read_b32 v31, v31 offset:12288
    s_add_u32 s69, s66, s61
    s_and_b32 s69, s69, 1023
    s_lshl_b32 s69, s69, 12
    v_add_u32 v5, s69, v1
    s_waitcnt vmcnt(0) lgkmcnt(0)
    buffer_load_dwordx4 v[64:67], v5, s[44:47], 0 offen offset:0 nt
    buffer_load_dwordx4 v[68:71], v5, s[44:47], 0 offen offset:1024 nt
    buffer_load_dwordx4 v[72:75], v5, s[44:47], 0 offen offset:2048 nt
    buffer_load_dwordx4 v[76:79], v5, s[44:47], 0 offen offset:3072 nt
    s_mov_b64 exec, 1
    ds_add_rtn_u32 v4, v2, v3 offset:4
    s_mov_b64 exec, -1
    v_mfma_f32_16x16x32_bf16 v[20:23], v[32:35], v[240:243], v[20:23]
    v_mfma_f32_16x16x32_bf16 v[20:23], v[36:39], v[244:247], v[20:23]
    v_mfma_f32_16x16x32_bf16 v[20:23], v[40:43], v[248:251], v[20:23]
    v_mfma_f32_16x16x32_bf16 v[20:23], v[44:47], v[252:255], v[20:23]
    v_and_b32_dpp v32, v31, v16 row_newbcast:0 row_mask:0xf bank_mask:0xf
    v_and_b32_dpp v33, v31, v17 row_newbcast:0 row_mask:0xf bank_mask:0xf
    v_and_b32_dpp v34, v31, v18 row_newbcast:0 row_mask:0xf bank_mask:0xf
    v_and_b32_dpp v35, v31, v19 row_newbcast:0 row_mask:0xf bank_mask:0xf
    v_and_b32_dpp v36, v31, v16 row_newbcast:8 row_mask:0xf bank_mask:0xf
    v_and_b32_dpp v37, v31, v17 row_newbcast:8 row_mask:0xf bank_mask:0xf
    v_and_b32_dpp v38, v31, v18 row_newbcast:8 row_mask:0xf bank_mask:0xf
    v_and_b32_dpp v39, v31, v19 row_newbcast:8 row_mask:0xf bank_mask:0xf
    v_and_b32_dpp v40, v31, v16 row_newbcast:4 row_mask:0xf bank_mask:0xf
    v_and_b32_dpp v41, v31, v17 row_newbcast:4 row_mask:0xf bank_mask:0xf
    v_and_b32_dpp v42, v31, v18 row_newbcast:4 row_mask:0xf bank_mask:0xf
    v_and_b32_dpp v43, v31, v19 row_newbcast:4 row_mask:0xf bank_mask:0xf
    v_and_b32_dpp v44, v31, v16 row_newbcast:12 row_mask:0xf bank_mask:0xf
    v_and_b32_dpp v45, v31, v17 row_newbcast:12 row_mask:0xf bank_mask:0xf
    v_and_b32_dpp v46, v31, v18 row_newbcast:12 row_mask:0xf bank_mask:0xf
    v_and_b32_dpp v47, v31, v19 row_newbcast:12 row_mask:0xf bank_mask:0xf
    s_waitcnt lgkmcnt(0)
    v_readfirstlane_b32 s66, v4
    s_cmp_ge_u32 s66, 120
    s_cbranch_scc1 L_din1
    s_lshl_b32 s68, s66, 6
    v_add_u32 v31, s68, v6
    ds_read_b32 v31, v31 offset:12288
    s_add_u32 s69, s66, s61
    s_and_b32 s69, s69, 1023
    s_lshl_b32 s69, s69, 12
    v_add_u32 v5, s69, v1
    s_waitcnt vmcnt(0) lgkmcnt(0)
    buffer_load_dwordx4 v[240:243], v5, s[44:47], 0 offen offset:0 nt
    buffer_load_dwordx4 v[244:247], v5, s[44:47], 0 offen offset:1024 nt
    buffer_load_dwordx4 v[248:251], v5, s[44:47], 0 offen offset:2048 nt
    buffer_load_dwordx4 v[252:255], v5, s[44:47], 0 offen offset:3072 nt
    s_mov_b64 exec, 1
    ds_add_rtn_u32 v4, v2, v3 offset:4
    s_mov_b64 exec, -1
    v_mfma_f32_16x16x32_bf16 v[20:23], v[32:35], v[64:67], v[20:23]
    v_mfma_f32_16x16x32_bf16 v[20:23], v[36:39], v[68:71], v[20:23]
    v_mfma_f32_16x16x32_bf16 v[20:23], v[40:43], v[72:75], v[20:23]
    v_mfma_f32_16x16x32_bf16 v[20:23], v[44:47], v[76:79], v[20:23]
    v_and_b32_dpp v32, v31, v16 row_newbcast:0 row_mask:0xf bank_mask:0xf
    v_and_b32_dpp v33, v31, v17 row_newbcast:0 row_mask:0xf bank_mask:0xf
    v_and_b32_dpp v34, v31, v18 row_newbcast:0 row_mask:0xf bank_mask:0xf
    v_and_b32_dpp v35, v31, v19 row_newbcast:0 row_mask:0xf bank_mask:0xf
    v_and_b32_dpp v36, v31, v16 row_newbcast:8 row_mask:0xf bank_mask:0xf
    v_and_b32_dpp v37, v31, v17 row_newbcast:8 row_mask:0xf bank_mask:0xf
    v_and_b32_dpp v38, v31, v18 row_newbcast:8 row_mask:0xf bank_mask:0xf
    v_and_b32_dpp v39, v31, v19 row_newbcast:8 row_mask:0xf bank_mask:0xf
    v_and_b32_dpp v40, v31, v16 row_newbcast:4 row_mask:0xf bank_mask:0xf
    v_and_b32_dpp v41, v31, v17 row_newbcast:4 row_mask:0xf bank_mask:0xf
    v_and_b32_dpp v42, v31, v18 row_newbcast:4 row_mask:0xf bank_mask:0xf
    v_and_b32_dpp v43, v31, v19 row_newbcast:4 row_mask:0xf bank_mask:0xf
    v_and_b32_dpp v44, v31, v16 row_newbcast:12 row_mask:0xf bank_mask:0xf
    v_and_b32_dpp v45, v31, v17 row_newbcast:12 row_mask:0xf bank_mask:0xf
    v_and_b32_dpp v46, v31, v18 row_newbcast:12 row_mask:0xf bank_mask:0xf
    v_and_b32_dpp v47, v31, v19 row_newbcast:12 row_mask:0xf bank_mask:0xf
    s_branch L_v0
L_din0:
    s_mov_b32 s66, 1
    s_atomic_add s66, s[38:39], 0 glc
    s_branch L_d0
L_din1:
    s_mov_b32 s66, 1
    s_atomic_add s66, s[38:39], 0 glc
    s_branch L_d1
L_d0:
    s_waitcnt lgkmcnt(0)
    s_cmp_ge_u32 s66, 64
    s_cbranch_scc1 L_vend0
    s_and_b32 s68, s66, 7
    s_lshr_b32 s67, s66, 3
    s_lshl_b32 s69, s68, 5
    s_add_u32 s69, s69, s67
    s_lshl_b32 s69, s69, 5
    s_load_dwordx8 s[52:59], s[14:15], s69 glc
    s_lshl_b32 s68, s68, 7
    s_add_u32 s68, s68, s67
    s_add_u32 s68, s68, 120
    s_add_u32 s69, s68, s37
    s_and_b32 s69, s69, 1023
    s_lshl_b32 s69, s69, 12
    v_add_u32 v5, s69, v1
    s_cmp_ge_u32 s66, s29
    s_cselect_b32 s60, 64, 0
    s_cselect_b32 s66, 0, 1
    s_waitcnt vmcnt(0)
    buffer_load_dwordx4 v[64:67], v5, s[44:47], 0 offen offset:0 nt
    buffer_load_dwordx4 v[68:71], v5, s[44:47], 0 offen offset:1024 nt
    buffer_load_dwordx4 v[72:75], v5, s[44:47], 0 offen offset:2048 nt
    buffer_load_dwordx4 v[76:79], v5, s[44:47], 0 offen offset:3072 nt
    v_mfma_f32_16x16x32_bf16 v[20:23], v[32:35], v[240:243], v[20:23]
    v_mfma_f32_16x16x32_bf16 v[20:23], v[36:39], v[244:247], v[20:23]
    v_mfma_f32_16x16x32_bf16 v[20:23], v[40:43], v[248:251], v[20:23]
    v_mfma_f32_16x16x32_bf16 v[20:23], v[44:47], v[252:255], v[20:23]
    s_waitcnt lgkmcnt(0)
    s_atomic_add s66, s[38:39], 0 glc
    s_mov_b64 exec, 0xff
    v_lshlrev_b32 v31, v8, s52
    s_lshl_b64 exec, exec, 8
    v_lshlrev_b32 v31, v8, s53
    s_lshl_b64 exec, exec, 8
    v_lshlrev_b32 v31, v8, s54
    s_lshl_b64 exec, exec, 8
    v_lshlrev_b32 v31, v8, s55
    s_lshl_b64 exec, exec, 8
    v_lshlrev_b32 v31, v8, s56
    s_lshl_b64 exec, exec, 8
    v_lshlrev_b32 v31, v8, s57
    s_lshl_b64 exec, exec, 8
    v_lshlrev_b32 v31, v8, s58
    s_lshl_b64 exec, exec, 8
    v_lshlrev_b32 v31, v8, s59
    s_mov_b64 exec, -1
    v_and_b32 v31, 0xffff0000, v31
    v_fma_f32 v31, v31, s62, -v30
    v_exp_f32 v31, v31
    s_nop 0
    v_cvt_pk_bf16_f32 v31, v31, v31
    s_nop 1
    v_and_b32_dpp v32, v31, v16 row_newbcast:0 row_mask:0xf bank_mask:0xf
    v_and_b32_dpp v33, v31, v17 row_newbcast:0 row_mask:0xf bank_mask:0xf
    v_and_b32_dpp v34, v31, v18 row_newbcast:0 row_mask:0xf bank_mask:0xf
    v_and_b32_dpp v35, v31, v19 row_newbcast:0 row_mask:0xf bank_mask:0xf
    v_and_b32_dpp v36, v31, v16 row_newbcast:8 row_mask:0xf bank_mask:0xf
    v_and_b32_dpp v37, v31, v17 row_newbcast:8 row_mask:0xf bank_mask:0xf
    v_and_b32_dpp v38, v31, v18 row_newbcast:8 row_mask:0xf bank_mask:0xf
    v_and_b32_dpp v39, v31, v19 row_newbcast:8 row_mask:0xf bank_mask:0xf
    v_and_b32_dpp v40, v31, v16 row_newbcast:4 row_mask:0xf bank_mask:0xf
    v_and_b32_dpp v41, v31, v17 row_newbcast:4 row_mask:0xf bank_mask:0xf
    v_and_b32_dpp v42, v31, v18 row_newbcast:4 row_mask:0xf bank_mask:0xf
    v_and_b32_dpp v43, v31, v19 row_newbcast:4 row_mask:0xf bank_mask:0xf
    v_and_b32_dpp v44, v31, v16 row_newbcast:12 row_mask:0xf bank_mask:0xf
    v_and_b32_dpp v45, v31, v17 row_newbcast:12 row_mask:0xf bank_mask:0xf
    v_and_b32_dpp v46, v31, v18 row_newbcast:12 row_mask:0xf bank_mask:0xf
    v_and_b32_dpp v47, v31, v19 row_newbcast:12 row_mask:0xf bank_mask:0xf
L_d1:
    s_waitcnt lgkmcnt(0)
    s_cmp_ge_u32 s66, 64
    s_cbranch_scc1 L_vend1
    s_and_b32 s68, s66, 7
    s_lshr_b32 s67, s66, 3
    s_lshl_b32 s69, s68, 5
    s_add_u32 s69, s69, s67
    s_lshl_b32 s69, s69, 5
    s_load_dwordx8 s[52:59], s[14:15], s69 glc
    s_lshl_b32 s68, s68, 7
    s_add_u32 s68, s68, s67
    s_add_u32 s68, s68, 120
    s_add_u32 s69, s68, s37
    s_and_b32 s69, s69, 1023
    s_lshl_b32 s69, s69, 12
    v_add_u32 v5, s69, v1
    s_cmp_ge_u32 s66, s29
    s_cselect_b32 s60, 64, 0
    s_cselect_b32 s66, 0, 1
    s_waitcnt vmcnt(0)
    buffer_load_dwordx4 v[240:243], v5, s[44:47], 0 offen offset:0 nt
    buffer_load_dwordx4 v[244:247], v5, s[44:47], 0 offen offset:1024 nt
    buffer_load_dwordx4 v[248:251], v5, s[44:47], 0 offen offset:2048 nt
    buffer_load_dwordx4 v[252:255], v5, s[44:47], 0 offen offset:3072 nt
    v_mfma_f32_16x16x32_bf16 v[20:23], v[32:35], v[64:67], v[20:23]
    v_mfma_f32_16x16x32_bf16 v[20:23], v[36:39], v[68:71], v[20:23]
    v_mfma_f32_16x16x32_bf16 v[20:23], v[40:43], v[72:75], v[20:23]
    v_mfma_f32_16x16x32_bf16 v[20:23], v[44:47], v[76:79], v[20:23]
    s_waitcnt lgkmcnt(0)
    s_atomic_add s66, s[38:39], 0 glc
    s_mov_b64 exec, 0xff
    v_lshlrev_b32 v31, v8, s52
    s_lshl_b64 exec, exec, 8
    v_lshlrev_b32 v31, v8, s53
    s_lshl_b64 exec, exec, 8
    v_lshlrev_b32 v31, v8, s54
    s_lshl_b64 exec, exec, 8
    v_lshlrev_b32 v31, v8, s55
    s_lshl_b64 exec, exec, 8
    v_lshlrev_b32 v31, v8, s56
    s_lshl_b64 exec, exec, 8
    v_lshlrev_b32 v31, v8, s57
    s_lshl_b64 exec, exec, 8
    v_lshlrev_b32 v31, v8, s58
    s_lshl_b64 exec, exec, 8
    v_lshlrev_b32 v31, v8, s59
    s_mov_b64 exec, -1
    v_and_b32 v31, 0xffff0000, v31
    v_fma_f32 v31, v31, s62, -v30
    v_exp_f32 v31, v31
    s_nop 0
    v_cvt_pk_bf16_f32 v31, v31, v31
    s_nop 1
    v_and_b32_dpp v32, v31, v16 row_newbcast:0 row_mask:0xf bank_mask:0xf
    v_and_b32_dpp v33, v31, v17 row_newbcast:0 row_mask:0xf bank_mask:0xf
    v_and_b32_dpp v34, v31, v18 row_newbcast:0 row_mask:0xf bank_mask:0xf
    v_and_b32_dpp v35, v31, v19 row_newbcast:0 row_mask:0xf bank_mask:0xf
    v_and_b32_dpp v36, v31, v16 row_newbcast:8 row_mask:0xf bank_mask:0xf
    v_and_b32_dpp v37, v31, v17 row_newbcast:8 row_mask:0xf bank_mask:0xf
    v_and_b32_dpp v38, v31, v18 row_newbcast:8 row_mask:0xf bank_mask:0xf
    v_and_b32_dpp v39, v31, v19 row_newbcast:8 row_mask:0xf bank_mask:0xf
    v_and_b32_dpp v40, v31, v16 row_newbcast:4 row_mask:0xf bank_mask:0xf
    v_and_b32_dpp v41, v31, v17 row_newbcast:4 row_mask:0xf bank_mask:0xf
    v_and_b32_dpp v42, v31, v18 row_newbcast:4 row_mask:0xf bank_mask:0xf
    v_and_b32_dpp v43, v31, v19 row_newbcast:4 row_mask:0xf bank_mask:0xf
    v_and_b32_dpp v44, v31, v16 row_newbcast:12 row_mask:0xf bank_mask:0xf
    v_and_b32_dpp v45, v31, v17 row_newbcast:12 row_mask:0xf bank_mask:0xf
    v_and_b32_dpp v46, v31, v18 row_newbcast:12 row_mask:0xf bank_mask:0xf
    v_and_b32_dpp v47, v31, v19 row_newbcast:12 row_mask:0xf bank_mask:0xf
    s_branch L_d0
L_vend0:
    s_mov_b64 exec, 1
    ds_add_rtn_u32 v4, v2, v3 offset:20
    s_mov_b64 exec, -1
    s_lshl_b32 s69, s3, 9
    v_lshrrev_b32 v48, 1, v10
    v_add_u32 v48, s69, v48
    s_waitcnt vmcnt(0)
    v_mfma_f32_16x16x32_bf16 v[20:23], v[32:35], v[240:243], v[20:23]
    v_mfma_f32_16x16x32_bf16 v[20:23], v[36:39], v[244:247], v[20:23]
    v_mfma_f32_16x16x32_bf16 v[20:23], v[40:43], v[248:251], v[20:23]
    v_mfma_f32_16x16x32_bf16 v[20:23], v[44:47], v[252:255], v[20:23]
    s_branch L_last
L_vend1:
    s_mov_b64 exec, 1
    ds_add_rtn_u32 v4, v2, v3 offset:20
    s_mov_b64 exec, -1
    s_lshl_b32 s69, s3, 9
    v_lshrrev_b32 v48, 1, v10
    v_add_u32 v48, s69, v48
    s_waitcnt vmcnt(0)
    v_mfma_f32_16x16x32_bf16 v[20:23], v[32:35], v[64:67], v[20:23]
    v_mfma_f32_16x16x32_bf16 v[20:23], v[36:39], v[68:71], v[20:23]
    v_mfma_f32_16x16x32_bf16 v[20:23], v[40:43], v[72:75], v[20:23]
    v_mfma_f32_16x16x32_bf16 v[20:23], v[44:47], v[76:79], v[20:23]
L_last:
    s_nop 7
    ds_write_b64 v48, v[20:21] offset:512
    s_waitcnt lgkmcnt(0)
    v_readfirstlane_b32 s66, v4
    s_cmp_ge_u32 s66, 4
    s_cbranch_scc1 L_pfdone
    s_mul_i32 s66, s66, 5120
    s_mov_b32 s52, s12
    s_mov_b32 s53, s13
    s_mov_b32 s54, 5242880
    s_mov_b32 s55, 0x20000
    s_and_b32 s68, s35, 24
    s_add_u32 s68, s68, s36
    s_mul_i32 s68, s68, 163840
    s_and_b32 s69, s35, 7
    s_mul_i32 s69, s69, 20480
    s_add_u32 s68, s68, s69
    s_add_u32 s68, s68, s66
    buffer_load_dwordx4 v[108:111], v1, s[52:55], s68 offen offset:0
    buffer_load_dwordx4 v[108:111], v1, s[52:55], s68 offen offset:1024
    buffer_load_dwordx4 v[108:111], v1, s[52:55], s68 offen offset:2048
    buffer_load_dwordx4 v[108:111], v1, s[52:55], s68 offen offset:3072
    s_add_u32 s68, s68, 4096
    buffer_load_dwordx4 v[108:111], v1, s[52:55], s68 offen offset:0
L_pfdone:
L_join:
    s_barrier
    s_cmp_lt_u32 s35, 17
    s_cbranch_scc1 L_pf2done
    s_sub_u32 s66, s35, 17
    s_mul_i32 s66, s66, 7
    s_add_u32 s66, s66, s3
    s_sub_u32 s66, s66, 1
    s_cmp_ge_u32 s66, 80
    s_cbranch_scc1 L_end
    s_mov_b32 s52, s16
    s_mov_b32 s53, s17
    s_mov_b32 s54, 2211840
    s_mov_b32 s55, 0x20000
    s_mov_b32 s56, s18
    s_mov_b32 s57, s19
    s_mov_b32 s58, 2211840
    s_mov_b32 s59, 0x20000
    v_lshrrev_b32 v49, 5, v9
    v_mul_u32_u24 v49, 3456, v49
    v_and_b32 v50, 31, v9
    v_lshl_add_u32 v49, v50, 4, v49
    s_mul_i32 s68, s36, 7
    s_lshr_b32 s68, s68, 1
    s_min_u32 s68, s68, 23
    s_lshl_b32 s68, s68, 7
    s_mul_i32 s69, s66, 20736
    s_add_u32 s68, s68, s69
    s_add_u32 s68, s68, 552960
    buffer_load_dwordx4 v[108:111], v49, s[52:55], s68 offen
    s_waitcnt vmcnt(2)
    buffer_load_dwordx4 v[108:111], v49, s[56:59], s68 offen
    s_waitcnt vmcnt(2)
    s_add_u32 s68, s68, 6912
    buffer_load_dwordx4 v[108:111], v49, s[52:55], s68 offen
    s_waitcnt vmcnt(2)
    buffer_load_dwordx4 v[108:111], v49, s[56:59], s68 offen
    s_waitcnt vmcnt(2)
    s_add_u32 s68, s68, 6912
    buffer_load_dwordx4 v[108:111], v49, s[52:55], s68 offen
    s_waitcnt vmcnt(2)
    buffer_load_dwordx4 v[108:111], v49, s[56:59], s68 offen
    s_waitcnt vmcnt(2)
    s_mov_b32 s52, s20
    s_mov_b32 s53, s21
    s_mov_b32 s54, 2211840
    s_mov_b32 s55, 0x20000
    s_mul_i32 s68, s36, 286720
    s_mul_i32 s69, s66, 3584
    s_add_u32 s68, s68, s69
    v_add_u32 v49, s68, v1
    buffer_load_dwordx4 v[108:111], v49, s[52:55], 0 offen offset:0
    s_waitcnt vmcnt(2)
    buffer_load_dwordx4 v[108:111], v49, s[52:55], 0 offen offset:1024
    s_waitcnt vmcnt(2)
    buffer_load_dwordx4 v[108:111], v49, s[52:55], 0 offen offset:2048
    s_waitcnt vmcnt(2)
    s_mov_b32 exec_hi, 0
    buffer_load_dwordx4 v[108:111], v49, s[52:55], 0 offen offset:3072
    s_waitcnt vmcnt(2)
    s_waitcnt vmcnt(0)
    s_endpgm
L_pf2done:
L_tail0:
    s_cmp_ge_u32 s65, 54
    s_cbranch_scc1 L_nomap
    s_xor_b32 s68, s3, 4
    s_and_b32 s69, s3, 3
    s_cselect_b32 s3, s68, s3
L_nomap:
    s_cmp_lt_u32 s35, 10
    s_cbranch_scc1 L_lwo_5
    s_cmp_ge_u32 s65, 54
    s_cbranch_scc1 L_ldone_6
    s_cmp_gt_u32 s3, 3
    s_cbranch_scc1 L_ldone_6
    v_and_b32 v34, 4, v9
    v_cmp_eq_u32 vcc, 0, v34
    v_mov_b32 v34, s18
    v_mov_b32 v35, s16
    v_cndmask_b32 v38, v34, v35, vcc
    v_mov_b32 v34, s19
    v_mov_b32 v35, s17
    v_cndmask_b32 v39, v34, v35, vcc
    s_mul_i32 s69, s3, 552960
    s_lshl_b32 s68, s65, 6
    s_add_u32 s69, s69, s68
    v_and_b32 v36, 3, v9
    v_lshl_add_u32 v36, v36, 4, s69
    v_lshrrev_b32 v37, 3, v9
    v_mul_u32_u24 v33, 55296, v37
    v_add_u32 v33, v33, v36
    v_add_co_u32 v34, vcc, v38, v33
    s_nop 1
    v_addc_co_u32 v35, vcc, 0, v39, vcc
    global_load_dwordx4 v[112:115], v[34:35], off offset:0
    global_load_dwordx4 v[128:131], v[34:35], off offset:3456
    v_add_co_u32 v34, vcc, 6912, v34
    s_nop 1
    v_addc_co_u32 v35, vcc, 0, v35, vcc
    global_load_dwordx4 v[144:147], v[34:35], off offset:0
    global_load_dwordx4 v[160:163], v[34:35], off offset:3456
    v_add_co_u32 v34, vcc, 6912, v34
    s_nop 1
    v_addc_co_u32 v35, vcc, 0, v35, vcc
    global_load_dwordx4 v[116:119], v[34:35], off offset:0
    global_load_dwordx4 v[132:135], v[34:35], off offset:3456
    v_add_co_u32 v34, vcc, 6912, v34
    s_nop 1
    v_addc_co_u32 v35, vcc, 0, v35, vcc
    global_load_dwordx4 v[148:151], v[34:35], off offset:0
    global_load_dwordx4 v[164:167], v[34:35], off offset:3456
    v_add_co_u32 v34, vcc, 6912, v34
    s_nop 1
    v_addc_co_u32 v35, vcc, 0, v35, vcc
    global_load_dwordx4 v[120:123], v[34:35], off offset:0
    global_load_dwordx4 v[136:139], v[34:35], off offset:3456
    v_add_co_u32 v34, vcc, 6912, v34
    s_nop 1
    v_addc_co_u32 v35, vcc, 0, v35, vcc
    global_load_dwordx4 v[152:155], v[34:35], off offset:0
    global_load_dwordx4 v[168:171], v[34:35], off offset:3456
    v_add_co_u32 v34, vcc, 6912, v34
    s_nop 1
    v_addc_co_u32 v35, vcc, 0, v35, vcc
    global_load_dwordx4 v[124:127], v[34:35], off offset:0
    global_load_dwordx4 v[140:143], v[34:35], off offset:3456
    v_add_co_u32 v34, vcc, 6912, v34
    s_nop 1
    v_addc_co_u32 v35, vcc, 0, v35, vcc
    global_load_dwordx4 v[156:159], v[34:35], off offset:0
    global_load_dwordx4 v[172:175], v[34:35], off offset:3456
    v_mul_u32_u24 v33, 13824, v37
    v_add_u32 v33, v33, v36
    v_add_u32 v33, 442368, v33
    v_add_co_u32 v34, vcc, v38, v33
    s_nop 1
    v_addc_co_u32 v35, vcc, 0, v39, vcc
    global_load_dwordx4 v[176:179], v[34:35], off offset:0
    global_load_dwordx4 v[180:183], v[34:35], off offset:3456
    v_add_co_u32 v34, vcc, 6912, v34
    s_nop 1
    v_addc_co_u32 v35, vcc, 0, v35, vcc
    global_load_dwordx4 v[184:187], v[34:35], off offset:0
    global_load_dwordx4 v[188:191], v[34:35], off offset:3456
    s_branch L_ldone_6
L_lwo_5:
    s_mov_b32 s52, s12
    s_mov_b32 s53, s13
    s_mov_b32 s54, 5242880
    s_mov_b32 s55, 0x20000
    v_bfe_u32 v49, v9, 4, 1
    v_lshlrev_b32 v49, 5, v49
    v_lshrrev_b32 v50, 5, v9
    v_add_u32 v49, v49, v50
    v_bfe_u32 v50, v9, 3, 1
    v_lshl_add_u32 v49, v50, 4, v49
    v_mul_u32_u24 v49, 1280, v49
    v_and_b32 v50, 7, v9
    v_lshl_add_u32 v49, v50, 4, v49
    s_lshr_b32 s68, s3, 1
    s_lshl_b32 s68, s68, 3
    s_add_u32 s68, s68, s36
    s_lshl_b32 s68, s68, 1
    s_and_b32 s69, s3, 1
    s_add_u32 s68, s68, s69
    s_mul_i32 s69, s68, 81920
    s_lshl_b32 s68, s35, 7
    s_add_u32 s69, s69, s68
    s_add_u32 s68, s69, 0
    buffer_load_dwordx4 v[112:115], v49, s[52:55], s68 offen offset:0
    buffer_load_dwordx4 v[116:119], v49, s[52:55], s68 offen offset:2560
    s_add_u32 s68, s69, 5120
    buffer_load_dwordx4 v[120:123], v49, s[52:55], s68 offen offset:0
    buffer_load_dwordx4 v[124:127], v49, s[52:55], s68 offen offset:2560
    s_add_u32 s68, s69, 10240
    buffer_load_dwordx4 v[128:131], v49, s[52:55], s68 offen offset:0
    buffer_load_dwordx4 v[132:135], v49, s[52:55], s68 offen offset:2560
    s_add_u32 s68, s69, 15360
    buffer_load_dwordx4 v[136:139], v49, s[52:55], s68 offen offset:0
    buffer_load_dwordx4 v[140:143], v49, s[52:55], s68 offen offset:2560
L_ldone_6:
L_tail:
    ds_read_b32 v11, v2 offset:36
    s_waitcnt lgkmcnt(0)
    v_readfirstlane_b32 s28, v11
    s_cmp_lt_u32 s35, 10
    s_cbranch_scc1 L_wo
    s_cmp_ge_u32 s65, 54
    s_cbranch_scc1 L_exit
    s_cmp_gt_u32 s3, 3
    s_cbranch_scc1 L_gprep
    v_lshrrev_b32 v48, 3, v9
    v_and_b32 v49, 3, v9
    v_lshl_add_u32 v49, v48, 2, v49
    s_mul_i32 s68, s3, 640
    v_lshl_add_u32 v56, v49, 4, s68
    s_add_u32 s68, s68, 512
    v_lshl_add_u32 v57, v49, 2, s68
    ds_read_b128 v[100:103], v56 offset:23040
    ds_read_b32 v29, v57 offset:23040
    ds_read_b128 v[12:15], v56 offset:25600
    ds_read_b32 v28, v57 offset:25600
    v_and_b32 v53, 7, v9
    v_lshlrev_b32 v53, 5, v53
    v_and_b32 v59, 16, v9
    v_add_u32 v53, v53, v59
    v_lshrrev_b32 v59, 5, v9
    v_lshl_add_u32 v53, v59, 8, v53
    s_lshl_b32 s68, s3, 9
    v_add_u32 v53, s68, v53
    s_min_u32 s21, s65, 39
    v_and_b32 v3, 7, v9
    v_lshrrev_b32 v49, 5, v9
    v_lshl_add_u32 v3, v3, 3, v49
    s_lshr_b32 s68, s21, 3
    s_lshl_b32 s68, s68, 7
    s_and_b32 s69, s21, 1
    s_lshl_b32 s69, s69, 6
    s_add_u32 s68, s68, s69
    s_and_b32 s69, s21, 6
    s_add_u32 s68, s68, s69
    v_add_u32 v3, s68, v3
    v_lshlrev_b32 v4, 2, v3
    v_lshlrev_b32 v3, 1, v3
    ds_read_b32 v6, v4 offset:28160
    s_lshr_b32 s13, s28, s36
    s_and_b32 s13, s13, 1
    s_lshl_b32 s13, s13, 13
    s_lshl_b32 s68, s21, 14
    s_add_u32 s13, s13, s68
    s_add_u32 s13, s13, 3145728
    s_add_u32 s14, s13, 4096
    s_waitcnt lgkmcnt(0)
    s_waitcnt vmcnt(0)
    s_cmp_lg_u32 s3, 0
    s_cbranch_scc1 L_gemv
    s_mov_b32 s23, 4
    v_and_b32 v48, 31, v9
    v_lshrrev_b32 v49, 5, v9
    v_lshl_add_u32 v50, v48, 1, v49
    s_lshl_b32 s68, s23, 6
    v_add_u32 v50, s68, v50
    v_lshlrev_b32 v51, 3, v50
    ds_read_b64 v[26:27], v51 offset:20480
    ds_read_b64 v[24:25], v51 offset:8192
    v_mul_u32_u24 v52, 2560, v49
    v_lshl_add_u32 v52, v48, 4, v52
    s_lshl_b32 s68, s23, 9
    v_add_u32 v52, s68, v52
    s_lshr_b32 s68, s28, s36
    s_and_b32 s68, s68, 1
    s_lshl_b32 s68, s68, 13
    s_lshl_b32 s69, s36, 16
    s_add_u32 s68, s68, s69
    s_add_u32 s4, s68, 2621440
    s_add_u32 s5, s68, 2637824
    s_add_u32 s6, s68, 2654208
    s_add_u32 s7, s68, 2670592
    s_lshl_b32 s68, s23, 3
    v_mov_b32 v5, s68
    v_mov_b32 v30, 0x3f80
    v_mov_b32 v31, 0x3f800000
    s_waitcnt lgkmcnt(0)
    s_mov_b32 s64, 0x40000
L_poll_7:
    buffer_load_dwordx4 v[64:67], v52, s[48:51], s4 offen offset:0 sc1
    buffer_load_dwordx4 v[68:71], v52, s[48:51], s5 offen offset:0 sc1
    buffer_load_dwordx4 v[72:75], v52, s[48:51], s6 offen offset:0 sc1
    buffer_load_dwordx4 v[76:79], v52, s[48:51], s7 offen offset:0 sc1
    s_waitcnt vmcnt(3)
    v_xor_b32 v11, s34, v65
    v_bitop3_b32 v11, v11, v67, s34 bitop3:0xf6
    s_waitcnt vmcnt(2)
    v_bitop3_b32 v11, v11, v69, s34 bitop3:0xf6
    v_bitop3_b32 v11, v11, v71, s34 bitop3:0xf6
    s_waitcnt vmcnt(1)
    v_bitop3_b32 v11, v11, v73, s34 bitop3:0xf6
    v_bitop3_b32 v11, v11, v75, s34 bitop3:0xf6
    s_waitcnt vmcnt(0)
    v_bitop3_b32 v11, v11, v77, s34 bitop3:0xf6
    v_bitop3_b32 v11, v11, v79, s34 bitop3:0xf6
    v_cmp_ne_u32 vcc, 0, v11
    s_cbranch_vccz L_pdone_8
    s_sub_u32 s64, s64, 1
    s_cmp_lg_u32 s64, 0
    s_cbranch_scc1 L_poll_7
L_pdone_8:
    v_dot2_f32_bf16 v96, v64, v30, 0
    v_dot2_f32_bf16 v97, v64, v31, 0
    v_dot2_f32_bf16 v98, v66, v30, 0
    v_dot2_f32_bf16 v99, v66, v31, 0
    v_dot2c_f32_bf16 v96, v68, v30
    v_dot2c_f32_bf16 v97, v68, v31
    v_dot2c_f32_bf16 v98, v70, v30
    v_dot2c_f32_bf16 v99, v70, v31
    v_dot2c_f32_bf16 v96, v72, v30
    v_dot2c_f32_bf16 v97, v72, v31
    v_dot2c_f32_bf16 v98, v74, v30
    v_dot2c_f32_bf16 v99, v74, v31
    v_dot2c_f32_bf16 v96, v76, v30
    v_dot2c_f32_bf16 v97, v76, v31
    v_dot2c_f32_bf16 v98, v78, v30
    v_dot2c_f32_bf16 v99, v78, v31
    s_nop 1
    v_permlane32_swap_b32 v96, v98
    v_permlane32_swap_b32 v97, v99
    v_pk_add_f32 v[96:97], v[96:97], v[98:99]
    v_pk_fma_f32 v[24:25], v[96:97], v[26:27], v[24:25]
    v_cvt_pk_bf16_f32 v25, v24, v25
    v_lshlrev_b32 v24, 16, v25
    v_and_b32 v25, 0xffff0000, v25
    v_add_f32 v96, v24, v25
    v_mul_f32 v97, v24, v24
    v_fmac_f32 v97, v25, v25
    ds_write_b64 v51, v[24:25] offset:8192
    v_add_f32_dpp v96, v96, v96 quad_perm:[1,0,3,2] row_mask:0xf bank_mask:0xf
    v_add_f32_dpp v97, v97, v97 quad_perm:[1,0,3,2] row_mask:0xf bank_mask:0xf
    s_nop 0
    v_add_f32_dpp v96, v96, v96 quad_perm:[2,3,0,1] row_mask:0xf bank_mask:0xf
    v_add_f32_dpp v97, v97, v97 quad_perm:[2,3,0,1] row_mask:0xf bank_mask:0xf
    s_nop 0
    v_add_f32_dpp v96, v96, v96 row_ror:4 row_mask:0xf bank_mask:0xf
    v_add_f32_dpp v97, v97, v97 row_ror:4 row_mask:0xf bank_mask:0xf
    s_nop 0
    v_add_f32_dpp v96, v96, v96 row_ror:8 row_mask:0xf bank_mask:0xf
    v_add_f32_dpp v97, v97, v97 row_ror:8 row_mask:0xf bank_mask:0xf
    s_nop 0
    v_add_f32_dpp v96, v96, v96 row_bcast:15 row_mask:0xa bank_mask:0xf
    v_add_f32_dpp v97, v97, v97 row_bcast:15 row_mask:0xa bank_mask:0xf
    s_nop 0
    v_add_f32_dpp v96, v96, v96 row_bcast:31 row_mask:0xc bank_mask:0xf
    v_add_f32_dpp v97, v97, v97 row_bcast:31 row_mask:0xc bank_mask:0xf
    s_mov_b32 exec_lo, 0
    s_brev_b32 exec_hi, 1
    ds_write_b64 v5, v[96:97] offset:512
    s_mov_b64 exec, -1
    s_waitcnt lgkmcnt(0)
L_gemv:
    s_barrier
    ds_read_b128 v[32:35], v2 offset:512
    ds_read_b128 v[36:39], v2 offset:528
    ds_read_b64 v[40:41], v2 offset:544
    ds_read_b128 v[104:107], v56 offset:8192
    ds_read_b32 v108, v57 offset:8192
    v_mov_b32 v98, 0x3727c5ac
    s_waitcnt lgkmcnt(2)
    v_pk_add_f32 v[32:33], v[32:33], v[34:35]
    v_pk_add_f32 v[36:37], v[36:37], v[38:39]
    v_pk_add_f32 v[32:33], v[32:33], v[36:37]
    v_pk_add_f32 v[96:97], v[32:33], v[40:41]
    v_mul_f32 v96, 0x3acccccd, v96
    v_fmac_f32 v98, 0x3acccccd, v97
    v_fma_f32 v98, -v96, v96, v98
    v_max_f32 v98, 0x3727c5ac, v98
    v_rsq_f32 v98, v98
    v_cvt_pk_bf16_f32 v96, v96, v96
    v_and_b32 v96, 0xffff0000, v96
    s_waitcnt lgkmcnt(0)
    v_sub_f32 v104, v104, v96
    v_sub_f32 v105, v105, v96
    v_sub_f32 v106, v106, v96
    v_sub_f32 v107, v107, v96
    v_sub_f32 v108, v108, v96
    v_mul_f32 v104, v104, v12
    v_mul_f32 v105, v105, v13
    v_mul_f32 v106, v106, v14
    v_mul_f32 v107, v107, v15
    v_mul_f32 v108, v108, v28
    v_fmac_f32 v100, v104, v98
    v_fmac_f32 v101, v105, v98
    v_fmac_f32 v102, v106, v98
    v_fmac_f32 v103, v107, v98
    v_fmac_f32 v29, v108, v98
    v_cvt_pk_bf16_f32 v100, v100, v100
    v_cvt_pk_bf16_f32 v101, v101, v101
    v_cvt_pk_bf16_f32 v102, v102, v102
    v_cvt_pk_bf16_f32 v103, v103, v103
    v_cvt_pk_bf16_f32 v29, v29, v29
    v_and_b32_dpp v32, v100, v60 quad_perm:[0,0,0,0] row_mask:0xf bank_mask:0xf
    v_and_b32_dpp v33, v100, v61 quad_perm:[0,0,0,0] row_mask:0xf bank_mask:0xf
    v_and_b32_dpp v34, v100, v62 quad_perm:[0,0,0,0] row_mask:0xf bank_mask:0xf
    v_and_b32_dpp v35, v100, v63 quad_perm:[0,0,0,0] row_mask:0xf bank_mask:0xf
    v_and_b32_dpp v36, v100, v60 quad_perm:[1,1,1,1] row_mask:0xf bank_mask:0xf
    v_and_b32_dpp v37, v100, v61 quad_perm:[1,1,1,1] row_mask:0xf bank_mask:0xf
    v_and_b32_dpp v38, v100, v62 quad_perm:[1,1,1,1] row_mask:0xf bank_mask:0xf
    v_and_b32_dpp v39, v100, v63 quad_perm:[1,1,1,1] row_mask:0xf bank_mask:0xf
    v_mfma_f32_16x16x32_bf16 v[20:23], v[32:35], v[112:115], 0
    v_and_b32_dpp v40, v100, v60 quad_perm:[2,2,2,2] row_mask:0xf bank_mask:0xf
    v_and_b32_dpp v41, v100, v61 quad_perm:[2,2,2,2] row_mask:0xf bank_mask:0xf
    v_and_b32_dpp v42, v100, v62 quad_perm:[2,2,2,2] row_mask:0xf bank_mask:0xf
    v_and_b32_dpp v43, v100, v63 quad_perm:[2,2,2,2] row_mask:0xf bank_mask:0xf
    v_mfma_f32_16x16x32_bf16 v[20:23], v[36:39], v[116:119], v[20:23]
    v_and_b32_dpp v44, v100, v60 quad_perm:[3,3,3,3] row_mask:0xf bank_mask:0xf
    v_and_b32_dpp v45, v100, v61 quad_perm:[3,3,3,3] row_mask:0xf bank_mask:0xf
    v_and_b32_dpp v46, v100, v62 quad_perm:[3,3,3,3] row_mask:0xf bank_mask:0xf
    v_and_b32_dpp v47, v100, v63 quad_perm:[3,3,3,3] row_mask:0xf bank_mask:0xf
    v_mfma_f32_16x16x32_bf16 v[20:23], v[40:43], v[120:123], v[20:23]
    v_and_b32_dpp v32, v101, v60 quad_perm:[0,0,0,0] row_mask:0xf bank_mask:0xf
    v_and_b32_dpp v33, v101, v61 quad_perm:[0,0,0,0] row_mask:0xf bank_mask:0xf
    v_and_b32_dpp v34, v101, v62 quad_perm:[0,0,0,0] row_mask:0xf bank_mask:0xf
    v_and_b32_dpp v35, v101, v63 quad_perm:[0,0,0,0] row_mask:0xf bank_mask:0xf
    v_mfma_f32_16x16x32_bf16 v[20:23], v[44:47], v[124:127], v[20:23]
    v_and_b32_dpp v36, v101, v60 quad_perm:[1,1,1,1] row_mask:0xf bank_mask:0xf
    v_and_b32_dpp v37, v101, v61 quad_perm:[1,1,1,1] row_mask:0xf bank_mask:0xf
    v_and_b32_dpp v38, v101, v62 quad_perm:[1,1,1,1] row_mask:0xf bank_mask:0xf
    v_and_b32_dpp v39, v101, v63 quad_perm:[1,1,1,1] row_mask:0xf bank_mask:0xf
    v_mfma_f32_16x16x32_bf16 v[20:23], v[32:35], v[128:131], v[20:23]
    v_and_b32_dpp v40, v101, v60 quad_perm:[2,2,2,2] row_mask:0xf bank_mask:0xf
    v_and_b32_dpp v41, v101, v61 quad_perm:[2,2,2,2] row_mask:0xf bank_mask:0xf
    v_and_b32_dpp v42, v101, v62 quad_perm:[2,2,2,2] row_mask:0xf bank_mask:0xf
    v_and_b32_dpp v43, v101, v63 quad_perm:[2,2,2,2] row_mask:0xf bank_mask:0xf
    v_mfma_f32_16x16x32_bf16 v[20:23], v[36:39], v[132:135], v[20:23]
    v_and_b32_dpp v44, v101, v60 quad_perm:[3,3,3,3] row_mask:0xf bank_mask:0xf
    v_and_b32_dpp v45, v101, v61 quad_perm:[3,3,3,3] row_mask:0xf bank_mask:0xf
    v_and_b32_dpp v46, v101, v62 quad_perm:[3,3,3,3] row_mask:0xf bank_mask:0xf
    v_and_b32_dpp v47, v101, v63 quad_perm:[3,3,3,3] row_mask:0xf bank_mask:0xf
    v_mfma_f32_16x16x32_bf16 v[20:23], v[40:43], v[136:139], v[20:23]
    v_and_b32_dpp v32, v102, v60 quad_perm:[0,0,0,0] row_mask:0xf bank_mask:0xf
    v_and_b32_dpp v33, v102, v61 quad_perm:[0,0,0,0] row_mask:0xf bank_mask:0xf
    v_and_b32_dpp v34, v102, v62 quad_perm:[0,0,0,0] row_mask:0xf bank_mask:0xf
    v_and_b32_dpp v35, v102, v63 quad_perm:[0,0,0,0] row_mask:0xf bank_mask:0xf
    v_mfma_f32_16x16x32_bf16 v[20:23], v[44:47], v[140:143], v[20:23]
    v_and_b32_dpp v36, v102, v60 quad_perm:[1,1,1,1] row_mask:0xf bank_mask:0xf
    v_and_b32_dpp v37, v102, v61 quad_perm:[1,1,1,1] row_mask:0xf bank_mask:0xf
    v_and_b32_dpp v38, v102, v62 quad_perm:[1,1,1,1] row_mask:0xf bank_mask:0xf
    v_and_b32_dpp v39, v102, v63 quad_perm:[1,1,1,1] row_mask:0xf bank_mask:0xf
    v_mfma_f32_16x16x32_bf16 v[20:23], v[32:35], v[144:147], v[20:23]
    v_and_b32_dpp v40, v102, v60 quad_perm:[2,2,2,2] row_mask:0xf bank_mask:0xf
    v_and_b32_dpp v41, v102, v61 quad_perm:[2,2,2,2] row_mask:0xf bank_mask:0xf
    v_and_b32_dpp v42, v102, v62 quad_perm:[2,2,2,2] row_mask:0xf bank_mask:0xf
    v_and_b32_dpp v43, v102, v63 quad_perm:[2,2,2,2] row_mask:0xf bank_mask:0xf
    v_mfma_f32_16x16x32_bf16 v[20:23], v[36:39], v[148:151], v[20:23]
    v_and_b32_dpp v44, v102, v60 quad_perm:[3,3,3,3] row_mask:0xf bank_mask:0xf
    v_and_b32_dpp v45, v102, v61 quad_perm:[3,3,3,3] row_mask:0xf bank_mask:0xf
    v_and_b32_dpp v46, v102, v62 quad_perm:[3,3,3,3] row_mask:0xf bank_mask:0xf
    v_and_b32_dpp v47, v102, v63 quad_perm:[3,3,3,3] row_mask:0xf bank_mask:0xf
    v_mfma_f32_16x16x32_bf16 v[20:23], v[40:43], v[152:155], v[20:23]
    v_and_b32_dpp v32, v103, v60 quad_perm:[0,0,0,0] row_mask:0xf bank_mask:0xf
    v_and_b32_dpp v33, v103, v61 quad_perm:[0,0,0,0] row_mask:0xf bank_mask:0xf
    v_and_b32_dpp v34, v103, v62 quad_perm:[0,0,0,0] row_mask:0xf bank_mask:0xf
    v_and_b32_dpp v35, v103, v63 quad_perm:[0,0,0,0] row_mask:0xf bank_mask:0xf
    v_mfma_f32_16x16x32_bf16 v[20:23], v[44:47], v[156:159], v[20:23]
    v_and_b32_dpp v36, v103, v60 quad_perm:[1,1,1,1] row_mask:0xf bank_mask:0xf
    v_and_b32_dpp v37, v103, v61 quad_perm:[1,1,1,1] row_mask:0xf bank_mask:0xf
    v_and_b32_dpp v38, v103, v62 quad_perm:[1,1,1,1] row_mask:0xf bank_mask:0xf
    v_and_b32_dpp v39, v103, v63 quad_perm:[1,1,1,1] row_mask:0xf bank_mask:0xf
    v_mfma_f32_16x16x32_bf16 v[20:23], v[32:35], v[160:163], v[20:23]
    v_and_b32_dpp v40, v103, v60 quad_perm:[2,2,2,2] row_mask:0xf bank_mask:0xf
    v_and_b32_dpp v41, v103, v61 quad_perm:[2,2,2,2] row_mask:0xf bank_mask:0xf
    v_and_b32_dpp v42, v103, v62 quad_perm:[2,2,2,2] row_mask:0xf bank_mask:0xf
    v_and_b32_dpp v43, v103, v63 quad_perm:[2,2,2,2] row_mask:0xf bank_mask:0xf
    v_mfma_f32_16x16x32_bf16 v[20:23], v[36:39], v[164:167], v[20:23]
    v_and_b32_dpp v44, v103, v60 quad_perm:[3,3,3,3] row_mask:0xf bank_mask:0xf
    v_and_b32_dpp v45, v103, v61 quad_perm:[3,3,3,3] row_mask:0xf bank_mask:0xf
    v_and_b32_dpp v46, v103, v62 quad_perm:[3,3,3,3] row_mask:0xf bank_mask:0xf
    v_and_b32_dpp v47, v103, v63 quad_perm:[3,3,3,3] row_mask:0xf bank_mask:0xf
    v_mfma_f32_16x16x32_bf16 v[20:23], v[40:43], v[168:171], v[20:23]
    v_and_b32_dpp v32, v29, v60 quad_perm:[0,0,0,0] row_mask:0xf bank_mask:0xf
    v_and_b32_dpp v33, v29, v61 quad_perm:[0,0,0,0] row_mask:0xf bank_mask:0xf
    v_and_b32_dpp v34, v29, v62 quad_perm:[0,0,0,0] row_mask:0xf bank_mask:0xf
    v_and_b32_dpp v35, v29, v63 quad_perm:[0,0,0,0] row_mask:0xf bank_mask:0xf
    v_mfma_f32_16x16x32_bf16 v[20:23], v[44:47], v[172:175], v[20:23]
    v_and_b32_dpp v36, v29, v60 quad_perm:[1,1,1,1] row_mask:0xf bank_mask:0xf
    v_and_b32_dpp v37, v29, v61 quad_perm:[1,1,1,1] row_mask:0xf bank_mask:0xf
    v_and_b32_dpp v38, v29, v62 quad_perm:[1,1,1,1] row_mask:0xf bank_mask:0xf
    v_and_b32_dpp v39, v29, v63 quad_perm:[1,1,1,1] row_mask:0xf bank_mask:0xf
    v_mfma_f32_16x16x32_bf16 v[20:23], v[32:35], v[176:179], v[20:23]
    v_and_b32_dpp v40, v29, v60 quad_perm:[2,2,2,2] row_mask:0xf bank_mask:0xf
    v_and_b32_dpp v41, v29, v61 quad_perm:[2,2,2,2] row_mask:0xf bank_mask:0xf
    v_and_b32_dpp v42, v29, v62 quad_perm:[2,2,2,2] row_mask:0xf bank_mask:0xf
    v_and_b32_dpp v43, v29, v63 quad_perm:[2,2,2,2] row_mask:0xf bank_mask:0xf
    v_mfma_f32_16x16x32_bf16 v[20:23], v[36:39], v[180:183], v[20:23]
    v_and_b32_dpp v44, v29, v60 quad_perm:[3,3,3,3] row_mask:0xf bank_mask:0xf
    v_and_b32_dpp v45, v29, v61 quad_perm:[3,3,3,3] row_mask:0xf bank_mask:0xf
    v_and_b32_dpp v46, v29, v62 quad_perm:[3,3,3,3] row_mask:0xf bank_mask:0xf
    v_and_b32_dpp v47, v29, v63 quad_perm:[3,3,3,3] row_mask:0xf bank_mask:0xf
    v_mfma_f32_16x16x32_bf16 v[20:23], v[40:43], v[184:187], v[20:23]
    s_nop 0
    v_mfma_f32_16x16x32_bf16 v[20:23], v[44:47], v[188:191], v[20:23]
    s_mov_b32 exec_lo, 0x00ff00ff
    s_mov_b32 exec_hi, 0xff00ff00
    s_nop 5
    ds_write_b128 v53, v[20:23] offset:4096
    s_mov_b64 exec, -1
    s_waitcnt lgkmcnt(0)
    s_barrier
    s_cmp_lg_u32 s3, 3
    s_cbranch_scc1 L_exit
    s_cmp_ge_u32 s65, 40
    s_cbranch_scc1 L_end
    ds_read_b32 v24, v4 offset:8192
    v_mov_b32 v88, 0
    v_mov_b32 v89, 0
    v_mov_b32 v91, s34
    s_mov_b32 s68, -1
    s_mov_b32 s69, 0xffff
    s_mov_b32 s56, s26
    s_mov_b32 s57, s27
    s_mov_b32 s58, 1280
    s_mov_b32 s59, 0x20000
    s_waitcnt lgkmcnt(0)
    s_barrier
    s_mov_b32 s64, 0x40000
L_poll_9:
    buffer_load_dwordx4 v[64:67], v1, s[48:51], s13 offen offset:0 sc1
    buffer_load_dwordx4 v[68:71], v1, s[48:51], s13 offen offset:1024 sc1
    buffer_load_dwordx4 v[72:75], v1, s[48:51], s13 offen offset:2048 sc1
    buffer_load_dwordx4 v[76:79], v1, s[48:51], s13 offen offset:3072 sc1
    buffer_load_dwordx4 v[80:83], v1, s[48:51], s14 offen offset:0 sc1
    buffer_load_dwordx4 v[84:87], v1, s[48:51], s14 offen offset:1024 sc1
    s_mov_b64 exec, s[68:69]
    buffer_load_dwordx4 v[88:91], v1, s[48:51], s14 offen offset:2048 sc1
    s_mov_b64 exec, -1
    s_waitcnt vmcnt(6)
    v_xor_b32 v11, s34, v67
    s_waitcnt vmcnt(5)
    v_bitop3_b32 v11, v11, v71, s34 bitop3:0xf6
    s_waitcnt vmcnt(4)
    v_bitop3_b32 v11, v11, v75, s34 bitop3:0xf6
    s_waitcnt vmcnt(3)
    v_bitop3_b32 v11, v11, v79, s34 bitop3:0xf6
    s_waitcnt vmcnt(2)
    v_bitop3_b32 v11, v11, v83, s34 bitop3:0xf6
    s_waitcnt vmcnt(1)
    v_bitop3_b32 v11, v11, v87, s34 bitop3:0xf6
    s_waitcnt vmcnt(0)
    v_bitop3_b32 v11, v11, v91, s34 bitop3:0xf6
    v_cmp_ne_u32 vcc, 0, v11
    s_cbranch_vccz L_pdone_10
    s_sub_u32 s64, s64, 1
    s_cmp_lg_u32 s64, 0
    s_cbranch_scc1 L_poll_9
L_pdone_10:
    v_pk_add_f32 v[64:65], v[64:65], v[68:69]
    v_pk_add_f32 v[72:73], v[72:73], v[76:77]
    v_pk_add_f32 v[80:81], v[80:81], v[84:85]
    v_pk_add_f32 v[64:65], v[64:65], v[72:73]
    v_pk_add_f32 v[80:81], v[80:81], v[88:89]
    v_pk_add_f32 v[26:27], v[64:65], v[80:81]
    s_nop 1
    v_permlane32_swap_b32 v26, v27
    v_add_f32 v26, v26, v27
    v_mov_b32 v27, v26
    s_nop 1
    v_permlane16_swap_b32 v26, v27
    v_add_f32 v26, v26, v27
    s_nop 1
    v_add_f32_dpp v26, v26, v26 row_ror:8 row_mask:0xf bank_mask:0xf
    v_fma_f32 v26, v26, v6, v24
    v_cvt_pk_bf16_f32 v26, v26, v26
    s_mov_b32 exec_lo, 0xff
    s_mov_b32 exec_hi, 0xff
    buffer_store_short v26, v3, s[56:59], 0 offen sc1
    s_cmp_lg_u32 s21, 0
    s_cbranch_scc1 L_fin_dump
    s_mov_b64 exec, 1
    v_mov_b32 v27, s34
    buffer_store_dword v27, v2, s[48:51], 0 offen sc1
L_fin_dump:
    s_endpgm
L_gprep:
    s_and_b32 s23, s3, 3
    v_and_b32 v48, 31, v9
    v_lshrrev_b32 v49, 5, v9
    v_lshl_add_u32 v50, v48, 1, v49
    s_lshl_b32 s68, s23, 6
    v_add_u32 v50, s68, v50
    v_lshlrev_b32 v51, 3, v50
    ds_read_b64 v[26:27], v51 offset:20480
    ds_read_b64 v[24:25], v51 offset:8192
    v_mul_u32_u24 v52, 2560, v49
    v_lshl_add_u32 v52, v48, 4, v52
    s_lshl_b32 s68, s23, 9
    v_add_u32 v52, s68, v52
    s_lshr_b32 s68, s28, s36
    s_and_b32 s68, s68, 1
    s_lshl_b32 s68, s68, 13
    s_lshl_b32 s69, s36, 16
    s_add_u32 s68, s68, s69
    s_add_u32 s4, s68, 2621440
    s_add_u32 s5, s68, 2637824
    s_add_u32 s6, s68, 2654208
    s_add_u32 s7, s68, 2670592
    s_lshl_b32 s68, s23, 3
    v_mov_b32 v5, s68
    v_mov_b32 v30, 0x3f80
    v_mov_b32 v31, 0x3f800000
    s_waitcnt lgkmcnt(0)
    s_mov_b32 s52, s20
    s_mov_b32 s53, s21
    s_mov_b32 s54, 2211840
    s_mov_b32 s55, 0x20000
    v_lshrrev_b32 v49, 4, v9
    v_mul_u32_u24 v49, 10240, v49
    v_and_b32 v50, 15, v9
    v_lshl_add_u32 v49, v50, 4, v49
    s_mul_i32 s60, s65, 40960
    s_lshl_b32 s68, s23, 8
    s_add_u32 s60, s60, s68
    v_lshrrev_b32 v54, 4, v9
    v_lshlrev_b32 v54, 3, v54
    v_and_b32 v55, 7, v9
    v_add_u32 v54, v54, v55
    v_bfe_u32 v55, v9, 3, 1
    v_lshl_add_u32 v54, v55, 5, v54
    v_lshlrev_b32 v54, 2, v54
    v_add_u32 v54, 4096, v54
    s_lshl_b32 s12, s65, 7
    s_add_u32 s12, s12, 3145728
    v_lshrrev_b32 v56, 3, v9
    s_lshl_b32 s68, s23, 3
    v_add_u32 v56, s68, v56
    v_mul_u32_u24 v55, 37, v56
    v_lshrrev_b32 v55, 8, v55
    v_lshrrev_b32 v55, v55, s28
    v_and_b32 v55, 1, v55
    v_lshl_add_u32 v56, v56, 1, v55
    v_lshlrev_b32 v56, 13, v56
    v_and_b32 v55, 7, v9
    v_lshl_add_u32 v56, v55, 4, v56
    v_lshrrev_b32 v57, 3, v9
    s_lshl_b32 s68, 4, 3
    v_add_u32 v57, s68, v57
    v_mul_u32_u24 v55, 37, v57
    v_lshrrev_b32 v55, 8, v55
    v_lshrrev_b32 v55, v55, s28
    v_and_b32 v55, 1, v55
    v_lshl_add_u32 v57, v57, 1, v55
    v_lshlrev_b32 v57, 13, v57
    v_and_b32 v55, 7, v9
    v_lshl_add_u32 v57, v55, 4, v57
    s_mov_b32 s64, 0x40000
L_poll_11:
    buffer_load_dwordx4 v[64:67], v52, s[48:51], s4 offen offset:0 sc1
    buffer_load_dwordx4 v[68:71], v52, s[48:51], s5 offen offset:0 sc1
    buffer_load_dwordx4 v[72:75], v52, s[48:51], s6 offen offset:0 sc1
    buffer_load_dwordx4 v[76:79], v52, s[48:51], s7 offen offset:0 sc1
    s_waitcnt vmcnt(3)
    v_xor_b32 v11, s34, v65
    v_bitop3_b32 v11, v11, v67, s34 bitop3:0xf6
    s_waitcnt vmcnt(2)
    v_bitop3_b32 v11, v11, v69, s34 bitop3:0xf6
    v_bitop3_b32 v11, v11, v71, s34 bitop3:0xf6
    s_waitcnt vmcnt(1)
    v_bitop3_b32 v11, v11, v73, s34 bitop3:0xf6
    v_bitop3_b32 v11, v11, v75, s34 bitop3:0xf6
    s_waitcnt vmcnt(0)
    v_bitop3_b32 v11, v11, v77, s34 bitop3:0xf6
    v_bitop3_b32 v11, v11, v79, s34 bitop3:0xf6
    v_cmp_ne_u32 vcc, 0, v11
    s_cbranch_vccz L_pdone_12
    s_sub_u32 s64, s64, 1
    s_cmp_lg_u32 s64, 0
    s_cbranch_scc1 L_poll_11
L_pdone_12:
    v_dot2_f32_bf16 v96, v64, v30, 0
    v_dot2_f32_bf16 v97, v64, v31, 0
    v_dot2_f32_bf16 v98, v66, v30, 0
    v_dot2_f32_bf16 v99, v66, v31, 0
    v_dot2c_f32_bf16 v96, v68, v30
    v_dot2c_f32_bf16 v97, v68, v31
    v_dot2c_f32_bf16 v98, v70, v30
    v_dot2c_f32_bf16 v99, v70, v31
    v_dot2c_f32_bf16 v96, v72, v30
    v_dot2c_f32_bf16 v97, v72, v31
    v_dot2c_f32_bf16 v98, v74, v30
    v_dot2c_f32_bf16 v99, v74, v31
    v_dot2c_f32_bf16 v96, v76, v30
    v_dot2c_f32_bf16 v97, v76, v31
    v_dot2c_f32_bf16 v98, v78, v30
    v_dot2c_f32_bf16 v99, v78, v31
    s_nop 1
    v_permlane32_swap_b32 v96, v98
    v_permlane32_swap_b32 v97, v99
    v_pk_add_f32 v[96:97], v[96:97], v[98:99]
    v_pk_fma_f32 v[24:25], v[96:97], v[26:27], v[24:25]
    v_cvt_pk_bf16_f32 v25, v24, v25
    v_lshlrev_b32 v24, 16, v25
    v_and_b32 v25, 0xffff0000, v25
    v_add_f32 v96, v24, v25
    v_mul_f32 v97, v24, v24
    v_fmac_f32 v97, v25, v25
    ds_write_b64 v51, v[24:25] offset:8192
    v_add_f32_dpp v96, v96, v96 quad_perm:[1,0,3,2] row_mask:0xf bank_mask:0xf
    v_add_f32_dpp v97, v97, v97 quad_perm:[1,0,3,2] row_mask:0xf bank_mask:0xf
    s_nop 0
    v_add_f32_dpp v96, v96, v96 quad_perm:[2,3,0,1] row_mask:0xf bank_mask:0xf
    v_add_f32_dpp v97, v97, v97 quad_perm:[2,3,0,1] row_mask:0xf bank_mask:0xf
    s_nop 0
    v_add_f32_dpp v96, v96, v96 row_ror:4 row_mask:0xf bank_mask:0xf
    v_add_f32_dpp v97, v97, v97 row_ror:4 row_mask:0xf bank_mask:0xf
    s_nop 0
    v_add_f32_dpp v96, v96, v96 row_ror:8 row_mask:0xf bank_mask:0xf
    v_add_f32_dpp v97, v97, v97 row_ror:8 row_mask:0xf bank_mask:0xf
    s_nop 0
    v_add_f32_dpp v96, v96, v96 row_bcast:15 row_mask:0xa bank_mask:0xf
    v_add_f32_dpp v97, v97, v97 row_bcast:15 row_mask:0xa bank_mask:0xf
    s_nop 0
    v_add_f32_dpp v96, v96, v96 row_bcast:31 row_mask:0xc bank_mask:0xf
    v_add_f32_dpp v97, v97, v97 row_bcast:31 row_mask:0xc bank_mask:0xf
    s_mov_b32 exec_lo, 0
    s_brev_b32 exec_hi, 1
    ds_write_b64 v5, v[96:97] offset:512
    s_mov_b64 exec, -1
    s_waitcnt lgkmcnt(0)
    s_barrier
    s_mov_b32 s69, s60
    s_add_u32 s68, s69, 0
    buffer_load_dwordx4 v[192:195], v49, s[52:55], s68 offen offset:0
    buffer_load_dwordx4 v[196:199], v49, s[52:55], s68 offen offset:1280
    s_add_u32 s68, s69, 2560
    buffer_load_dwordx4 v[200:203], v49, s[52:55], s68 offen offset:0
    buffer_load_dwordx4 v[204:207], v49, s[52:55], s68 offen offset:1280
    s_add_u32 s68, s69, 5120
    buffer_load_dwordx4 v[208:211], v49, s[52:55], s68 offen offset:0
    buffer_load_dwordx4 v[212:215], v49, s[52:55], s68 offen offset:1280
    s_add_u32 s68, s69, 7680
    buffer_load_dwordx4 v[216:219], v49, s[52:55], s68 offen offset:0
    buffer_load_dwordx4 v[220:223], v49, s[52:55], s68 offen offset:1280
    s_cmp_lg_u32 s3, 5
    s_cbranch_scc1 L_dnd1
    s_add_u32 s68, s69, 0
    buffer_load_dwordx4 v[224:227], v49, s[52:55], s68 offen offset:768
    buffer_load_dwordx4 v[228:231], v49, s[52:55], s68 offen offset:2048
    s_add_u32 s68, s69, 2560
    buffer_load_dwordx4 v[232:235], v49, s[52:55], s68 offen offset:768
    buffer_load_dwordx4 v[236:239], v49, s[52:55], s68 offen offset:2048
    s_add_u32 s68, s69, 5120
    buffer_load_dwordx4 v[240:243], v49, s[52:55], s68 offen offset:768
    buffer_load_dwordx4 v[244:247], v49, s[52:55], s68 offen offset:2048
    s_add_u32 s68, s69, 7680
    buffer_load_dwordx4 v[248:251], v49, s[52:55], s68 offen offset:768
    buffer_load_dwordx4 v[252:255], v49, s[52:55], s68 offen offset:2048
L_dnd1:
    s_barrier
    ds_read2st64_b32 v[112:113], v54 offset0:0 offset1:1
    ds_read2st64_b32 v[114:115], v54 offset0:2 offset1:3
    ds_read2st64_b32 v[116:117], v54 offset0:4 offset1:5
    ds_read2st64_b32 v[118:119], v54 offset0:6 offset1:7
    s_waitcnt lgkmcnt(0)
    v_pk_add_f32 v[112:113], v[112:113], v[114:115]
    v_pk_add_f32 v[116:117], v[116:117], v[118:119]
    v_pk_add_f32 v[112:113], v[112:113], v[116:117]
    v_add_f32 v112, v112, v113
    v_mul_f32 v114, 0xbfb8aa3b, v112
    v_exp_f32 v114, v114
    v_mul_f32_dpp v113, v112, v112 row_ror:8 row_mask:0xf bank_mask:0xf
    v_add_f32 v114, 1.0, v114
    v_rcp_f32 v114, v114
    s_nop 0
    v_mul_f32 v112, v113, v114
    v_cvt_pk_bf16_f32 v112, v112, v112
    s_waitcnt vmcnt(0)
    s_cmp_eq_u32 s3, 5
    s_cbranch_scc1 L_down2
    v_and_b32_dpp v32, v112, v16 row_newbcast:0 row_mask:0xf bank_mask:0xf
    v_and_b32_dpp v33, v112, v17 row_newbcast:0 row_mask:0xf bank_mask:0xf
    v_and_b32_dpp v34, v112, v18 row_newbcast:0 row_mask:0xf bank_mask:0xf
    v_and_b32_dpp v35, v112, v19 row_newbcast:0 row_mask:0xf bank_mask:0xf
    v_and_b32_dpp v36, v112, v16 row_newbcast:1 row_mask:0xf bank_mask:0xf
    v_and_b32_dpp v37, v112, v17 row_newbcast:1 row_mask:0xf bank_mask:0xf
    v_and_b32_dpp v38, v112, v18 row_newbcast:1 row_mask:0xf bank_mask:0xf
    v_and_b32_dpp v39, v112, v19 row_newbcast:1 row_mask:0xf bank_mask:0xf
    v_mfma_f32_16x16x32_bf16 v[20:23], v[32:35], v[192:195], 0
    v_and_b32_dpp v40, v112, v16 row_newbcast:2 row_mask:0xf bank_mask:0xf
    v_and_b32_dpp v41, v112, v17 row_newbcast:2 row_mask:0xf bank_mask:0xf
    v_and_b32_dpp v42, v112, v18 row_newbcast:2 row_mask:0xf bank_mask:0xf
    v_and_b32_dpp v43, v112, v19 row_newbcast:2 row_mask:0xf bank_mask:0xf
    v_mfma_f32_16x16x32_bf16 v[20:23], v[36:39], v[196:199], v[20:23]
    v_and_b32_dpp v44, v112, v16 row_newbcast:3 row_mask:0xf bank_mask:0xf
    v_and_b32_dpp v45, v112, v17 row_newbcast:3 row_mask:0xf bank_mask:0xf
    v_and_b32_dpp v46, v112, v18 row_newbcast:3 row_mask:0xf bank_mask:0xf
    v_and_b32_dpp v47, v112, v19 row_newbcast:3 row_mask:0xf bank_mask:0xf
    v_mfma_f32_16x16x32_bf16 v[20:23], v[40:43], v[200:203], v[20:23]
    v_and_b32_dpp v32, v112, v16 row_newbcast:4 row_mask:0xf bank_mask:0xf
    v_and_b32_dpp v33, v112, v17 row_newbcast:4 row_mask:0xf bank_mask:0xf
    v_and_b32_dpp v34, v112, v18 row_newbcast:4 row_mask:0xf bank_mask:0xf
    v_and_b32_dpp v35, v112, v19 row_newbcast:4 row_mask:0xf bank_mask:0xf
    v_mfma_f32_16x16x32_bf16 v[20:23], v[44:47], v[204:207], v[20:23]
    v_and_b32_dpp v36, v112, v16 row_newbcast:5 row_mask:0xf bank_mask:0xf
    v_and_b32_dpp v37, v112, v17 row_newbcast:5 row_mask:0xf bank_mask:0xf
    v_and_b32_dpp v38, v112, v18 row_newbcast:5 row_mask:0xf bank_mask:0xf
    v_and_b32_dpp v39, v112, v19 row_newbcast:5 row_mask:0xf bank_mask:0xf
    v_mfma_f32_16x16x32_bf16 v[20:23], v[32:35], v[208:211], v[20:23]
    v_and_b32_dpp v40, v112, v16 row_newbcast:6 row_mask:0xf bank_mask:0xf
    v_and_b32_dpp v41, v112, v17 row_newbcast:6 row_mask:0xf bank_mask:0xf
    v_and_b32_dpp v42, v112, v18 row_newbcast:6 row_mask:0xf bank_mask:0xf
    v_and_b32_dpp v43, v112, v19 row_newbcast:6 row_mask:0xf bank_mask:0xf
    v_mfma_f32_16x16x32_bf16 v[20:23], v[36:39], v[212:215], v[20:23]
    v_and_b32_dpp v44, v112, v16 row_newbcast:7 row_mask:0xf bank_mask:0xf
    v_and_b32_dpp v45, v112, v17 row_newbcast:7 row_mask:0xf bank_mask:0xf
    v_and_b32_dpp v46, v112, v18 row_newbcast:7 row_mask:0xf bank_mask:0xf
    v_and_b32_dpp v47, v112, v19 row_newbcast:7 row_mask:0xf bank_mask:0xf
    v_mfma_f32_16x16x32_bf16 v[20:23], v[40:43], v[216:219], v[20:23]
    s_nop 0
    v_mfma_f32_16x16x32_bf16 v[20:23], v[44:47], v[220:223], v[20:23]
    s_nop 7
    v_mov_b32 v23, s34
    buffer_store_dwordx4 v[20:23], v56, s[48:51], s12 offen sc1
    s_endpgm
L_down2:
    v_and_b32_dpp v32, v112, v16 row_newbcast:0 row_mask:0xf bank_mask:0xf
    v_and_b32_dpp v33, v112, v17 row_newbcast:0 row_mask:0xf bank_mask:0xf
    v_and_b32_dpp v34, v112, v18 row_newbcast:0 row_mask:0xf bank_mask:0xf
    v_and_b32_dpp v35, v112, v19 row_newbcast:0 row_mask:0xf bank_mask:0xf
    v_and_b32_dpp v36, v112, v16 row_newbcast:1 row_mask:0xf bank_mask:0xf
    v_and_b32_dpp v37, v112, v17 row_newbcast:1 row_mask:0xf bank_mask:0xf
    v_and_b32_dpp v38, v112, v18 row_newbcast:1 row_mask:0xf bank_mask:0xf
    v_and_b32_dpp v39, v112, v19 row_newbcast:1 row_mask:0xf bank_mask:0xf
    v_mfma_f32_16x16x32_bf16 v[20:23], v[32:35], v[192:195], 0
    v_mfma_f32_16x16x32_bf16 v[104:107], v[32:35], v[224:227], 0
    v_and_b32_dpp v40, v112, v16 row_newbcast:2 row_mask:0xf bank_mask:0xf
    v_and_b32_dpp v41, v112, v17 row_newbcast:2 row_mask:0xf bank_mask:0xf
    v_and_b32_dpp v42, v112, v18 row_newbcast:2 row_mask:0xf bank_mask:0xf
    v_and_b32_dpp v43, v112, v19 row_newbcast:2 row_mask:0xf bank_mask:0xf
    v_mfma_f32_16x16x32_bf16 v[20:23], v[36:39], v[196:199], v[20:23]
    v_mfma_f32_16x16x32_bf16 v[104:107], v[36:39], v[228:231], v[104:107]
    v_and_b32_dpp v44, v112, v16 row_newbcast:3 row_mask:0xf bank_mask:0xf
    v_and_b32_dpp v45, v112, v17 row_newbcast:3 row_mask:0xf bank_mask:0xf
    v_and_b32_dpp v46, v112, v18 row_newbcast:3 row_mask:0xf bank_mask:0xf
    v_and_b32_dpp v47, v112, v19 row_newbcast:3 row_mask:0xf bank_mask:0xf
    v_mfma_f32_16x16x32_bf16 v[20:23], v[40:43], v[200:203], v[20:23]
    v_mfma_f32_16x16x32_bf16 v[104:107], v[40:43], v[232:235], v[104:107]
    v_and_b32_dpp v32, v112, v16 row_newbcast:4 row_mask:0xf bank_mask:0xf
    v_and_b32_dpp v33, v112, v17 row_newbcast:4 row_mask:0xf bank_mask:0xf
    v_and_b32_dpp v34, v112, v18 row_newbcast:4 row_mask:0xf bank_mask:0xf
    v_and_b32_dpp v35, v112, v19 row_newbcast:4 row_mask:0xf bank_mask:0xf
    v_mfma_f32_16x16x32_bf16 v[20:23], v[44:47], v[204:207], v[20:23]
    v_mfma_f32_16x16x32_bf16 v[104:107], v[44:47], v[236:239], v[104:107]
    v_and_b32_dpp v36, v112, v16 row_newbcast:5 row_mask:0xf bank_mask:0xf
    v_and_b32_dpp v37, v112, v17 row_newbcast:5 row_mask:0xf bank_mask:0xf
    v_and_b32_dpp v38, v112, v18 row_newbcast:5 row_mask:0xf bank_mask:0xf
    v_and_b32_dpp v39, v112, v19 row_newbcast:5 row_mask:0xf bank_mask:0xf
    v_mfma_f32_16x16x32_bf16 v[20:23], v[32:35], v[208:211], v[20:23]
    v_mfma_f32_16x16x32_bf16 v[104:107], v[32:35], v[240:243], v[104:107]
    v_and_b32_dpp v40, v112, v16 row_newbcast:6 row_mask:0xf bank_mask:0xf
    v_and_b32_dpp v41, v112, v17 row_newbcast:6 row_mask:0xf bank_mask:0xf
    v_and_b32_dpp v42, v112, v18 row_newbcast:6 row_mask:0xf bank_mask:0xf
    v_and_b32_dpp v43, v112, v19 row_newbcast:6 row_mask:0xf bank_mask:0xf
    v_mfma_f32_16x16x32_bf16 v[20:23], v[36:39], v[212:215], v[20:23]
    v_mfma_f32_16x16x32_bf16 v[104:107], v[36:39], v[244:247], v[104:107]
    v_and_b32_dpp v44, v112, v16 row_newbcast:7 row_mask:0xf bank_mask:0xf
    v_and_b32_dpp v45, v112, v17 row_newbcast:7 row_mask:0xf bank_mask:0xf
    v_and_b32_dpp v46, v112, v18 row_newbcast:7 row_mask:0xf bank_mask:0xf
    v_and_b32_dpp v47, v112, v19 row_newbcast:7 row_mask:0xf bank_mask:0xf
    v_mfma_f32_16x16x32_bf16 v[20:23], v[40:43], v[216:219], v[20:23]
    v_mfma_f32_16x16x32_bf16 v[104:107], v[40:43], v[248:251], v[104:107]
    v_mfma_f32_16x16x32_bf16 v[20:23], v[44:47], v[220:223], v[20:23]
    v_mfma_f32_16x16x32_bf16 v[104:107], v[44:47], v[252:255], v[104:107]
    s_nop 6
    v_mov_b32 v23, s34
    v_mov_b32 v107, s34
    buffer_store_dwordx4 v[20:23], v56, s[48:51], s12 offen sc1
    buffer_store_dwordx4 v[104:107], v57, s[48:51], s12 offen sc1
    s_waitcnt vmcnt(0)
    s_barrier
    s_endpgm
L_wo:
    v_lshrrev_b32 v52, 5, v9
    v_lshlrev_b32 v52, 10, v52
    v_and_b32 v54, 31, v9
    v_lshl_add_u32 v52, v54, 4, v52
    s_lshr_b32 s4, s3, 1
    s_lshl_b32 s4, s4, 3
    s_add_u32 s4, s4, s36
    s_lshl_b32 s4, s4, 14
    s_lshr_b32 s5, s28, s36
    s_and_b32 s5, s5, 1
    s_lshl_b32 s5, s5, 13
    s_add_u32 s4, s4, s5
    s_and_b32 s5, s3, 1
    s_lshl_b32 s5, s5, 9
    s_add_u32 s4, s4, s5
    s_add_u32 s4, s4, 2097152
    s_add_u32 s5, s4, 4096
    v_and_b32 v53, 7, v9
    v_lshlrev_b32 v53, 5, v53
    v_and_b32 v59, 16, v9
    v_add_u32 v53, v53, v59
    v_lshrrev_b32 v59, 5, v9
    v_lshl_add_u32 v53, v59, 8, v53
    s_lshl_b32 s68, s3, 9
    v_add_u32 v53, s68, v53
    v_lshrrev_b32 v56, 5, v9
    v_lshlrev_b32 v55, 11, v56
    v_lshl_add_u32 v55, v54, 3, v55
    v_add_u32 v12, 0, v56
    v_lshrrev_b32 v57, v12, s28
    v_and_b32 v57, 1, v57
    v_lshl_add_u32 v12, v12, 3, v57
    v_lshlrev_b32 v12, 13, v12
    v_lshl_add_u32 v12, v54, 3, v12
    v_add_u32 v13, 2, v56
    v_lshrrev_b32 v57, v13, s28
    v_and_b32 v57, 1, v57
    v_lshl_add_u32 v13, v13, 3, v57
    v_lshlrev_b32 v13, 13, v13
    v_lshl_add_u32 v13, v54, 3, v13
    v_add_u32 v14, 4, v56
    v_lshrrev_b32 v57, v14, s28
    v_and_b32 v57, 1, v57
    v_lshl_add_u32 v14, v14, 3, v57
    v_lshlrev_b32 v14, 13, v14
    v_lshl_add_u32 v14, v54, 3, v14
    v_add_u32 v15, 6, v56
    v_lshrrev_b32 v57, v15, s28
    v_and_b32 v57, 1, v57
    v_lshl_add_u32 v15, v15, 3, v57
    v_lshlrev_b32 v15, 13, v15
    v_lshl_add_u32 v15, v54, 3, v15
    s_lshr_b32 s6, s36, 1
    s_lshl_b32 s6, s6, 14
    s_and_b32 s7, s36, 1
    s_mul_i32 s7, s7, 2560
    s_add_u32 s6, s6, s7
    s_lshl_b32 s7, s35, 8
    s_add_u32 s6, s6, s7
    s_add_u32 s6, s6, 2621440
    s_mov_b32 s64, 0x40000
L_poll_13:
    buffer_load_dwordx4 v[64:67], v52, s[48:51], s4 offen offset:0 sc1
    buffer_load_dwordx4 v[68:71], v52, s[48:51], s4 offen offset:2048 sc1
    buffer_load_dwordx4 v[72:75], v52, s[48:51], s5 offen offset:0 sc1
    buffer_load_dwordx4 v[76:79], v52, s[48:51], s5 offen offset:2048 sc1
    s_waitcnt vmcnt(3)
    v_xor_b32 v11, s34, v67
    s_waitcnt vmcnt(2)
    v_bitop3_b32 v11, v11, v71, s34 bitop3:0xf6
    s_waitcnt vmcnt(1)
    v_bitop3_b32 v11, v11, v75, s34 bitop3:0xf6
    s_waitcnt vmcnt(0)
    v_bitop3_b32 v11, v11, v79, s34 bitop3:0xf6
    v_cmp_ne_u32 vcc, 0, v11
    s_cbranch_vccz L_pdone_14
    s_sub_u32 s64, s64, 1
    s_cmp_lg_u32 s64, 0
    s_cbranch_scc1 L_poll_13
L_pdone_14:
    v_pk_add_f32 v[64:65], v[64:65], v[68:69]
    v_pk_add_f32 v[72:73], v[72:73], v[76:77]
    v_pk_add_f32 v[96:97], v[64:65], v[72:73]
    s_nop 1
    v_permlane32_swap_b32 v96, v97
    v_add_f32 v96, v96, v97
    v_cvt_pk_bf16_f32 v96, v96, v96
    v_mov_b32 v98, v96
    v_mov_b32 v99, v96
    s_nop 0
    v_mov_b32_dpp v98, v96 row_shr:4 row_mask:0xf bank_mask:0xa
    v_mov_b32_dpp v99, v96 row_shl:4 row_mask:0xf bank_mask:0x5
    s_nop 0
    v_and_b32_dpp v32, v98, v60 quad_perm:[0,0,0,0] row_mask:0xf bank_mask:0xf
    v_and_b32_dpp v33, v98, v61 quad_perm:[0,0,0,0] row_mask:0xf bank_mask:0xf
    v_and_b32_dpp v34, v98, v62 quad_perm:[0,0,0,0] row_mask:0xf bank_mask:0xf
    v_and_b32_dpp v35, v98, v63 quad_perm:[0,0,0,0] row_mask:0xf bank_mask:0xf
    v_and_b32_dpp v36, v98, v60 quad_perm:[1,1,1,1] row_mask:0xf bank_mask:0xf
    v_and_b32_dpp v37, v98, v61 quad_perm:[1,1,1,1] row_mask:0xf bank_mask:0xf
    v_and_b32_dpp v38, v98, v62 quad_perm:[1,1,1,1] row_mask:0xf bank_mask:0xf
    v_and_b32_dpp v39, v98, v63 quad_perm:[1,1,1,1] row_mask:0xf bank_mask:0xf
    v_mfma_f32_16x16x32_bf16 v[20:23], v[32:35], v[112:115], 0
    v_and_b32_dpp v40, v98, v60 quad_perm:[2,2,2,2] row_mask:0xf bank_mask:0xf
    v_and_b32_dpp v41, v98, v61 quad_perm:[2,2,2,2] row_mask:0xf bank_mask:0xf
    v_and_b32_dpp v42, v98, v62 quad_perm:[2,2,2,2] row_mask:0xf bank_mask:0xf
    v_and_b32_dpp v43, v98, v63 quad_perm:[2,2,2,2] row_mask:0xf bank_mask:0xf
    v_mfma_f32_16x16x32_bf16 v[20:23], v[36:39], v[116:119], v[20:23]
    v_and_b32_dpp v44, v98, v60 quad_perm:[3,3,3,3] row_mask:0xf bank_mask:0xf
    v_and_b32_dpp v45, v98, v61 quad_perm:[3,3,3,3] row_mask:0xf bank_mask:0xf
    v_and_b32_dpp v46, v98, v62 quad_perm:[3,3,3,3] row_mask:0xf bank_mask:0xf
    v_and_b32_dpp v47, v98, v63 quad_perm:[3,3,3,3] row_mask:0xf bank_mask:0xf
    v_mfma_f32_16x16x32_bf16 v[20:23], v[40:43], v[120:123], v[20:23]
    v_and_b32_dpp v32, v99, v60 quad_perm:[0,0,0,0] row_mask:0xf bank_mask:0xf
    v_and_b32_dpp v33, v99, v61 quad_perm:[0,0,0,0] row_mask:0xf bank_mask:0xf
    v_and_b32_dpp v34, v99, v62 quad_perm:[0,0,0,0] row_mask:0xf bank_mask:0xf
    v_and_b32_dpp v35, v99, v63 quad_perm:[0,0,0,0] row_mask:0xf bank_mask:0xf
    v_mfma_f32_16x16x32_bf16 v[20:23], v[44:47], v[124:127], v[20:23]
    v_and_b32_dpp v36, v99, v60 quad_perm:[1,1,1,1] row_mask:0xf bank_mask:0xf
    v_and_b32_dpp v37, v99, v61 quad_perm:[1,1,1,1] row_mask:0xf bank_mask:0xf
    v_and_b32_dpp v38, v99, v62 quad_perm:[1,1,1,1] row_mask:0xf bank_mask:0xf
    v_and_b32_dpp v39, v99, v63 quad_perm:[1,1,1,1] row_mask:0xf bank_mask:0xf
    v_mfma_f32_16x16x32_bf16 v[20:23], v[32:35], v[128:131], v[20:23]
    v_and_b32_dpp v40, v99, v60 quad_perm:[2,2,2,2] row_mask:0xf bank_mask:0xf
    v_and_b32_dpp v41, v99, v61 quad_perm:[2,2,2,2] row_mask:0xf bank_mask:0xf
    v_and_b32_dpp v42, v99, v62 quad_perm:[2,2,2,2] row_mask:0xf bank_mask:0xf
    v_and_b32_dpp v43, v99, v63 quad_perm:[2,2,2,2] row_mask:0xf bank_mask:0xf
    v_mfma_f32_16x16x32_bf16 v[20:23], v[36:39], v[132:135], v[20:23]
    v_and_b32_dpp v44, v99, v60 quad_perm:[3,3,3,3] row_mask:0xf bank_mask:0xf
    v_and_b32_dpp v45, v99, v61 quad_perm:[3,3,3,3] row_mask:0xf bank_mask:0xf
    v_and_b32_dpp v46, v99, v62 quad_perm:[3,3,3,3] row_mask:0xf bank_mask:0xf
    v_and_b32_dpp v47, v99, v63 quad_perm:[3,3,3,3] row_mask:0xf bank_mask:0xf
    v_mfma_f32_16x16x32_bf16 v[20:23], v[40:43], v[136:139], v[20:23]
    s_nop 0
    v_mfma_f32_16x16x32_bf16 v[20:23], v[44:47], v[140:143], v[20:23]
    s_mov_b32 exec_lo, 0x00ff00ff
    s_mov_b32 exec_hi, 0xff00ff00
    s_nop 5
    ds_write_b128 v53, v[20:23] offset:4096
    s_mov_b64 exec, -1
    s_waitcnt lgkmcnt(0)
    s_barrier
    s_cmp_lg_u32 s3, 0
    s_cbranch_scc1 L_end
    ds_read_b64 v[112:113], v55 offset:4096
    ds_read_b64 v[114:115], v55 offset:4352
    ds_read_b64 v[116:117], v55 offset:4608
    ds_read_b64 v[118:119], v55 offset:4864
    ds_read_b64 v[120:121], v55 offset:5120
    ds_read_b64 v[122:123], v55 offset:5376
    ds_read_b64 v[124:125], v55 offset:5632
    ds_read_b64 v[126:127], v55 offset:5888
    s_waitcnt lgkmcnt(0)
    v_pk_add_f32 v[112:113], v[112:113], v[114:115]
    v_pk_add_f32 v[116:117], v[116:117], v[118:119]
    v_pk_add_f32 v[120:121], v[120:121], v[122:123]
    v_pk_add_f32 v[124:125], v[124:125], v[126:127]
    v_pk_add_f32 v[112:113], v[112:113], v[116:117]
    v_pk_add_f32 v[120:121], v[120:121], v[124:125]
    v_pk_add_f32 v[112:113], v[112:113], v[120:121]
    v_mov_b32 v114, v112
    v_mov_b32 v115, v113
    s_nop 0
    v_permlane32_swap_b32 v112, v114
    v_permlane32_swap_b32 v113, v115
    v_pk_add_f32 v[112:113], v[112:113], v[114:115]
    v_cvt_pk_bf16_f32 v112, v112, v113
    v_mov_b32 v113, s34
    buffer_store_dwordx2 v[112:113], v12, s[48:51], s6 offen sc1
    buffer_store_dwordx2 v[112:113], v13, s[48:51], s6 offen sc1
    buffer_store_dwordx2 v[112:113], v14, s[48:51], s6 offen sc1
    buffer_store_dwordx2 v[112:113], v15, s[48:51], s6 offen sc1
L_exit:
    s_endpgm
L_help:
    s_waitcnt lgkmcnt(0)
    s_barrier
    s_cmp_lt_u32 s35, 24
    s_cbranch_scc1 L_hnoq
    s_sub_u32 s39, s3, 5
    s_bfe_u32 s68, s35, 0x10002
    s_add_u32 s68, s68, s39
    s_cmp_lt_u32 s68, 3
    s_cbranch_scc1 L_ctrl_q
    s_load_dword s34, s[30:31], 0
    s_mov_b32 s48, s30
    s_mov_b32 s49, s31
    s_mov_b32 s50, 3933184
    s_mov_b32 s51, 0x20000
    v_and_b32 v48, 1, v9
    v_lshlrev_b32 v48, 4, v48
    v_mov_b32 v49, 0xffff
    v_lshlrev_b32 v48, v48, v49
    v_bfe_u32 v49, v9, 1, 2
    v_bfe_u32 v50, v9, 1, 3
    v_cmp_eq_u32 vcc, 0, v49
    s_nop 1
    v_cndmask_b32 v60, 0, v48, vcc
    v_cmp_eq_u32 vcc, 0, v50
    s_nop 1
    v_cndmask_b32 v16, 0, v48, vcc
    v_cmp_eq_u32 vcc, 1, v49
    s_nop 1
    v_cndmask_b32 v61, 0, v48, vcc
    v_cmp_eq_u32 vcc, 2, v50
    s_nop 1
    v_cndmask_b32 v17, 0, v48, vcc
    v_cmp_eq_u32 vcc, 2, v49
    s_nop 1
    v_cndmask_b32 v62, 0, v48, vcc
    v_cmp_eq_u32 vcc, 4, v50
    s_nop 1
    v_cndmask_b32 v18, 0, v48, vcc
    v_cmp_eq_u32 vcc, 3, v49
    s_nop 1
    v_cndmask_b32 v63, 0, v48, vcc
    v_cmp_eq_u32 vcc, 6, v50
    s_nop 1
    v_cndmask_b32 v19, 0, v48, vcc
    v_and_b32 v48, 15, v9
    v_lshlrev_b32 v48, 6, v48
    v_and_b32 v49, 48, v9
    v_add_u32 v10, v48, v49
    s_waitcnt lgkmcnt(0)
    s_add_u32 s34, s34, 0x01010101
    v_lshlrev_b32 v48, 3, v9
    v_mov_b32 v20, 0
    v_mov_b32 v21, 0
    ds_write_b64 v48, v[20:21] offset:4608
    s_waitcnt lgkmcnt(0)
    s_mov_b64 exec, 1
    ds_add_u32 v2, v3 offset:24
    s_mov_b64 exec, -1
    s_branch L_soft
L_hnoq:
    s_sub_u32 s37, s35, 5
    s_cmp_ge_u32 s37, 5
    s_cbranch_scc1 L_hnomod
    s_lshl_b32 s37, s37, 3
    s_add_u32 s37, s37, s36
    s_lshr_b32 s38, s37, 1
    s_and_b32 s39, s37, 1
    s_mul_i32 s6, s39, 20480
    s_lshl_b32 s7, s38, 10
    s_add_u32 s6, s6, s7
    s_add_u32 s6, s6, 372736
    s_add_u32 s38, s38, 10
    s_lshl_b32 s39, s39, 1
    s_add_u32 s39, s39, s3
    s_sub_u32 s39, s39, 6
    s_mov_b32 s52, s24
    s_mov_b32 s53, s25
    s_mov_b32 s54, 4915200
    s_mov_b32 s55, 0x20000
    s_mov_b32 s56, s22
    s_mov_b32 s57, s23
    s_mov_b32 s58, 1280
    s_mov_b32 s59, 0x20000
    v_lshrrev_b32 v48, 4, v9
    v_mul_u32_u24 v48, 40, v48
    v_and_b32 v49, 15, v9
    v_add_u32 v50, v48, v49
    v_lshlrev_b32 v50, 1, v50
    v_and_b32 v51, 7, v9
    v_add_u32 v51, v48, v51
    v_lshlrev_b32 v51, 1, v51
    s_mul_i32 s69, s39, 320
    buffer_load_ushort v24, v50, s[56:59], s69 offen
    buffer_load_ushort v25, v50, s[56:59], s69 offen offset:32
    buffer_load_ushort v26, v51, s[56:59], s69 offen offset:64
    v_mul_u32_u24 v48, 7680, v48
    v_lshl_add_u32 v48, v49, 4, v48
    s_mul_i32 s69, s39, 1228800
    s_lshl_b32 s68, s38, 8
    s_add_u32 s68, s69, s68
    buffer_load_dwordx4 v[64:67], v48, s[52:55], s68 offen nt
    s_add_u32 s68, s68, 7680
    buffer_load_dwordx4 v[68:71], v48, s[52:55], s68 offen nt
    s_add_u32 s68, s68, 7680
    buffer_load_dwordx4 v[72:75], v48, s[52:55], s68 offen nt
    s_add_u32 s68, s68, 7680
    buffer_load_dwordx4 v[76:79], v48, s[52:55], s68 offen nt
    s_add_u32 s68, s68, 7680
    buffer_load_dwordx4 v[80:83], v48, s[52:55], s68 offen nt
    s_add_u32 s68, s68, 7680
    buffer_load_dwordx4 v[84:87], v48, s[52:55], s68 offen nt
    s_add_u32 s68, s68, 7680
    buffer_load_dwordx4 v[88:91], v48, s[52:55], s68 offen nt
    s_add_u32 s68, s68, 7680
    buffer_load_dwordx4 v[92:95], v48, s[52:55], s68 offen nt
    s_add_u32 s68, s68, 7680
    buffer_load_dwordx4 v[96:99], v48, s[52:55], s68 offen nt
    s_add_u32 s68, s68, 7680
    buffer_load_dwordx4 v[100:103], v48, s[52:55], s68 offen nt
    s_add_u32 s68, s68, 7680
    buffer_load_dwordx4 v[104:107], v48, s[52:55], s68 offen nt
    s_add_u32 s68, s68, 7680
    buffer_load_dwordx4 v[108:111], v48, s[52:55], s68 offen nt
    s_add_u32 s68, s68, 7680
    buffer_load_dwordx4 v[112:115], v48, s[52:55], s68 offen nt
    s_add_u32 s68, s68, 7680
    buffer_load_dwordx4 v[116:119], v48, s[52:55], s68 offen nt
    s_add_u32 s68, s68, 7680
    buffer_load_dwordx4 v[120:123], v48, s[52:55], s68 offen nt
    s_add_u32 s68, s68, 7680
    buffer_load_dwordx4 v[124:127], v48, s[52:55], s68 offen nt
    s_add_u32 s68, s68, 7680
    buffer_load_dwordx4 v[128:131], v48, s[52:55], s68 offen nt
    s_add_u32 s68, s68, 7680
    buffer_load_dwordx4 v[132:135], v48, s[52:55], s68 offen nt
    s_add_u32 s68, s68, 7680
    buffer_load_dwordx4 v[136:139], v48, s[52:55], s68 offen nt
    s_add_u32 s68, s68, 7680
    buffer_load_dwordx4 v[140:143], v48, s[52:55], s68 offen nt
    s_add_u32 s68, s68, 7680
    buffer_load_dwordx4 v[144:147], v48, s[52:55], s68 offen nt
    s_add_u32 s68, s68, 7680
    buffer_load_dwordx4 v[148:151], v48, s[52:55], s68 offen nt
    s_add_u32 s68, s68, 7680
    buffer_load_dwordx4 v[152:155], v48, s[52:55], s68 offen nt
    s_add_u32 s68, s68, 7680
    buffer_load_dwordx4 v[156:159], v48, s[52:55], s68 offen nt
    s_add_u32 s68, s68, 7680
    buffer_load_dwordx4 v[160:163], v48, s[52:55], s68 offen nt
    s_add_u32 s68, s68, 7680
    buffer_load_dwordx4 v[164:167], v48, s[52:55], s68 offen nt
    s_add_u32 s68, s68, 7680
    buffer_load_dwordx4 v[168:171], v48, s[52:55], s68 offen nt
    s_add_u32 s68, s68, 7680
    buffer_load_dwordx4 v[172:175], v48, s[52:55], s68 offen nt
    s_add_u32 s68, s68, 7680
    buffer_load_dwordx4 v[176:179], v48, s[52:55], s68 offen nt
    s_add_u32 s68, s68, 7680
    buffer_load_dwordx4 v[180:183], v48, s[52:55], s68 offen nt
    s_add_u32 s68, s68, 7680
    buffer_load_dwordx4 v[184:187], v48, s[52:55], s68 offen nt
    s_add_u32 s68, s68, 7680
    buffer_load_dwordx4 v[188:191], v48, s[52:55], s68 offen nt
    s_add_u32 s68, s68, 7680
    buffer_load_dwordx4 v[192:195], v48, s[52:55], s68 offen nt
    s_add_u32 s68, s68, 7680
    buffer_load_dwordx4 v[196:199], v48, s[52:55], s68 offen nt
    s_add_u32 s68, s68, 7680
    buffer_load_dwordx4 v[200:203], v48, s[52:55], s68 offen nt
    s_add_u32 s68, s68, 7680
    buffer_load_dwordx4 v[204:207], v48, s[52:55], s68 offen nt
    s_add_u32 s68, s68, 7680
    buffer_load_dwordx4 v[208:211], v48, s[52:55], s68 offen nt
    s_add_u32 s68, s68, 7680
    buffer_load_dwordx4 v[212:215], v48, s[52:55], s68 offen nt
    s_add_u32 s68, s68, 7680
    buffer_load_dwordx4 v[216:219], v48, s[52:55], s68 offen nt
    s_add_u32 s68, s68, 7680
    buffer_load_dwordx4 v[220:223], v48, s[52:55], s68 offen nt
    s_load_dword s34, s[30:31], 0
    s_mov_b32 s48, s30
    s_mov_b32 s49, s31
    s_mov_b32 s50, 3933184
    s_mov_b32 s51, 0x20000
    v_and_b32 v48, 1, v9
    v_lshlrev_b32 v48, 4, v48
    v_mov_b32 v49, 0xffff
    v_lshlrev_b32 v48, v48, v49
    v_bfe_u32 v49, v9, 1, 2
    v_bfe_u32 v50, v9, 1, 3
    v_cmp_eq_u32 vcc, 0, v49
    s_nop 1
    v_cndmask_b32 v60, 0, v48, vcc
    v_cmp_eq_u32 vcc, 0, v50
    s_nop 1
    v_cndmask_b32 v16, 0, v48, vcc
    v_cmp_eq_u32 vcc, 1, v49
    s_nop 1
    v_cndmask_b32 v61, 0, v48, vcc
    v_cmp_eq_u32 vcc, 2, v50
    s_nop 1
    v_cndmask_b32 v17, 0, v48, vcc
    v_cmp_eq_u32 vcc, 2, v49
    s_nop 1
    v_cndmask_b32 v62, 0, v48, vcc
    v_cmp_eq_u32 vcc, 4, v50
    s_nop 1
    v_cndmask_b32 v18, 0, v48, vcc
    v_cmp_eq_u32 vcc, 3, v49
    s_nop 1
    v_cndmask_b32 v63, 0, v48, vcc
    v_cmp_eq_u32 vcc, 6, v50
    s_nop 1
    v_cndmask_b32 v19, 0, v48, vcc
    v_and_b32 v48, 15, v9
    v_lshlrev_b32 v48, 6, v48
    v_and_b32 v49, 48, v9
    v_add_u32 v10, v48, v49
    s_waitcnt lgkmcnt(0)
    s_add_u32 s34, s34, 0x01010101
    s_waitcnt vmcnt(40)
    v_lshlrev_b32 v24, 16, v24
    v_mul_f32 v27, 0xbfb8aa3b, v24
    v_exp_f32 v27, v27
    s_nop 0
    v_add_f32 v27, 1.0, v27
    v_rcp_f32 v27, v27
    s_nop 0
    v_mul_f32 v24, v24, v27
    v_cvt_pk_bf16_f32 v24, v24, v24
    v_lshlrev_b32 v25, 16, v25
    v_mul_f32 v27, 0xbfb8aa3b, v25
    v_exp_f32 v27, v27
    s_nop 0
    v_add_f32 v27, 1.0, v27
    v_rcp_f32 v27, v27
    s_nop 0
    v_mul_f32 v25, v25, v27
    v_cvt_pk_bf16_f32 v25, v25, v25
    v_lshlrev_b32 v26, 16, v26
    v_mul_f32 v27, 0xbfb8aa3b, v26
    v_exp_f32 v27, v27
    s_nop 0
    v_add_f32 v27, 1.0, v27
    v_rcp_f32 v27, v27
    s_nop 0
    v_mul_f32 v26, v26, v27
    v_cvt_pk_bf16_f32 v26, v26, v26
    v_and_b32_dpp v32, v24, v16 row_newbcast:0 row_mask:0xf bank_mask:0xf
    v_and_b32_dpp v33, v24, v17 row_newbcast:0 row_mask:0xf bank_mask:0xf
    v_and_b32_dpp v34, v24, v18 row_newbcast:0 row_mask:0xf bank_mask:0xf
    v_and_b32_dpp v35, v24, v19 row_newbcast:0 row_mask:0xf bank_mask:0xf
    v_and_b32_dpp v36, v24, v16 row_newbcast:1 row_mask:0xf bank_mask:0xf
    v_and_b32_dpp v37, v24, v17 row_newbcast:1 row_mask:0xf bank_mask:0xf
    v_and_b32_dpp v38, v24, v18 row_newbcast:1 row_mask:0xf bank_mask:0xf
    v_and_b32_dpp v39, v24, v19 row_newbcast:1 row_mask:0xf bank_mask:0xf
    s_waitcnt vmcnt(39)
    v_mfma_f32_16x16x32_bf16 v[20:23], v[32:35], v[64:67], 0
    v_and_b32_dpp v40, v24, v16 row_newbcast:2 row_mask:0xf bank_mask:0xf
    v_and_b32_dpp v41, v24, v17 row_newbcast:2 row_mask:0xf bank_mask:0xf
    v_and_b32_dpp v42, v24, v18 row_newbcast:2 row_mask:0xf bank_mask:0xf
    v_and_b32_dpp v43, v24, v19 row_newbcast:2 row_mask:0xf bank_mask:0xf
    s_waitcnt vmcnt(38)
    v_mfma_f32_16x16x32_bf16 v[20:23], v[36:39], v[68:71], v[20:23]
    v_and_b32_dpp v44, v24, v16 row_newbcast:3 row_mask:0xf bank_mask:0xf
    v_and_b32_dpp v45, v24, v17 row_newbcast:3 row_mask:0xf bank_mask:0xf
    v_and_b32_dpp v46, v24, v18 row_newbcast:3 row_mask:0xf bank_mask:0xf
    v_and_b32_dpp v47, v24, v19 row_newbcast:3 row_mask:0xf bank_mask:0xf
    s_waitcnt vmcnt(37)
    v_mfma_f32_16x16x32_bf16 v[20:23], v[40:43], v[72:75], v[20:23]
    v_and_b32_dpp v32, v24, v16 row_newbcast:4 row_mask:0xf bank_mask:0xf
    v_and_b32_dpp v33, v24, v17 row_newbcast:4 row_mask:0xf bank_mask:0xf
    v_and_b32_dpp v34, v24, v18 row_newbcast:4 row_mask:0xf bank_mask:0xf
    v_and_b32_dpp v35, v24, v19 row_newbcast:4 row_mask:0xf bank_mask:0xf
    s_waitcnt vmcnt(36)
    v_mfma_f32_16x16x32_bf16 v[20:23], v[44:47], v[76:79], v[20:23]
    v_and_b32_dpp v36, v24, v16 row_newbcast:5 row_mask:0xf bank_mask:0xf
    v_and_b32_dpp v37, v24, v17 row_newbcast:5 row_mask:0xf bank_mask:0xf
    v_and_b32_dpp v38, v24, v18 row_newbcast:5 row_mask:0xf bank_mask:0xf
    v_and_b32_dpp v39, v24, v19 row_newbcast:5 row_mask:0xf bank_mask:0xf
    s_waitcnt vmcnt(35)
    v_mfma_f32_16x16x32_bf16 v[20:23], v[32:35], v[80:83], v[20:23]
    v_and_b32_dpp v40, v24, v16 row_newbcast:6 row_mask:0xf bank_mask:0xf
    v_and_b32_dpp v41, v24, v17 row_newbcast:6 row_mask:0xf bank_mask:0xf
    v_and_b32_dpp v42, v24, v18 row_newbcast:6 row_mask:0xf bank_mask:0xf
    v_and_b32_dpp v43, v24, v19 row_newbcast:6 row_mask:0xf bank_mask:0xf
    s_waitcnt vmcnt(34)
    v_mfma_f32_16x16x32_bf16 v[20:23], v[36:39], v[84:87], v[20:23]
    v_and_b32_dpp v44, v24, v16 row_newbcast:7 row_mask:0xf bank_mask:0xf
    v_and_b32_dpp v45, v24, v17 row_newbcast:7 row_mask:0xf bank_mask:0xf
    v_and_b32_dpp v46, v24, v18 row_newbcast:7 row_mask:0xf bank_mask:0xf
    v_and_b32_dpp v47, v24, v19 row_newbcast:7 row_mask:0xf bank_mask:0xf
    s_waitcnt vmcnt(33)
    v_mfma_f32_16x16x32_bf16 v[20:23], v[40:43], v[88:91], v[20:23]
    v_and_b32_dpp v32, v24, v16 row_newbcast:8 row_mask:0xf bank_mask:0xf
    v_and_b32_dpp v33, v24, v17 row_newbcast:8 row_mask:0xf bank_mask:0xf
    v_and_b32_dpp v34, v24, v18 row_newbcast:8 row_mask:0xf bank_mask:0xf
    v_and_b32_dpp v35, v24, v19 row_newbcast:8 row_mask:0xf bank_mask:0xf
    s_waitcnt vmcnt(32)
    v_mfma_f32_16x16x32_bf16 v[20:23], v[44:47], v[92:95], v[20:23]
    v_and_b32_dpp v36, v24, v16 row_newbcast:9 row_mask:0xf bank_mask:0xf
    v_and_b32_dpp v37, v24, v17 row_newbcast:9 row_mask:0xf bank_mask:0xf
    v_and_b32_dpp v38, v24, v18 row_newbcast:9 row_mask:0xf bank_mask:0xf
    v_and_b32_dpp v39, v24, v19 row_newbcast:9 row_mask:0xf bank_mask:0xf
    s_waitcnt vmcnt(31)
    v_mfma_f32_16x16x32_bf16 v[20:23], v[32:35], v[96:99], v[20:23]
    v_and_b32_dpp v40, v24, v16 row_newbcast:10 row_mask:0xf bank_mask:0xf
    v_and_b32_dpp v41, v24, v17 row_newbcast:10 row_mask:0xf bank_mask:0xf
    v_and_b32_dpp v42, v24, v18 row_newbcast:10 row_mask:0xf bank_mask:0xf
    v_and_b32_dpp v43, v24, v19 row_newbcast:10 row_mask:0xf bank_mask:0xf
    s_waitcnt vmcnt(30)
    v_mfma_f32_16x16x32_bf16 v[20:23], v[36:39], v[100:103], v[20:23]
    v_and_b32_dpp v44, v24, v16 row_newbcast:11 row_mask:0xf bank_mask:0xf
    v_and_b32_dpp v45, v24, v17 row_newbcast:11 row_mask:0xf bank_mask:0xf
    v_and_b32_dpp v46, v24, v18 row_newbcast:11 row_mask:0xf bank_mask:0xf
    v_and_b32_dpp v47, v24, v19 row_newbcast:11 row_mask:0xf bank_mask:0xf
    s_waitcnt vmcnt(29)
    v_mfma_f32_16x16x32_bf16 v[20:23], v[40:43], v[104:107], v[20:23]
    v_and_b32_dpp v32, v24, v16 row_newbcast:12 row_mask:0xf bank_mask:0xf
    v_and_b32_dpp v33, v24, v17 row_newbcast:12 row_mask:0xf bank_mask:0xf
    v_and_b32_dpp v34, v24, v18 row_newbcast:12 row_mask:0xf bank_mask:0xf
    v_and_b32_dpp v35, v24, v19 row_newbcast:12 row_mask:0xf bank_mask:0xf
    s_waitcnt vmcnt(28)
    v_mfma_f32_16x16x32_bf16 v[20:23], v[44:47], v[108:111], v[20:23]
    v_and_b32_dpp v36, v24, v16 row_newbcast:13 row_mask:0xf bank_mask:0xf
    v_and_b32_dpp v37, v24, v17 row_newbcast:13 row_mask:0xf bank_mask:0xf
    v_and_b32_dpp v38, v24, v18 row_newbcast:13 row_mask:0xf bank_mask:0xf
    v_and_b32_dpp v39, v24, v19 row_newbcast:13 row_mask:0xf bank_mask:0xf
    s_waitcnt vmcnt(27)
    v_mfma_f32_16x16x32_bf16 v[20:23], v[32:35], v[112:115], v[20:23]
    v_and_b32_dpp v40, v24, v16 row_newbcast:14 row_mask:0xf bank_mask:0xf
    v_and_b32_dpp v41, v24, v17 row_newbcast:14 row_mask:0xf bank_mask:0xf
    v_and_b32_dpp v42, v24, v18 row_newbcast:14 row_mask:0xf bank_mask:0xf
    v_and_b32_dpp v43, v24, v19 row_newbcast:14 row_mask:0xf bank_mask:0xf
    s_waitcnt vmcnt(26)
    v_mfma_f32_16x16x32_bf16 v[20:23], v[36:39], v[116:119], v[20:23]
    v_and_b32_dpp v44, v24, v16 row_newbcast:15 row_mask:0xf bank_mask:0xf
    v_and_b32_dpp v45, v24, v17 row_newbcast:15 row_mask:0xf bank_mask:0xf
    v_and_b32_dpp v46, v24, v18 row_newbcast:15 row_mask:0xf bank_mask:0xf
    v_and_b32_dpp v47, v24, v19 row_newbcast:15 row_mask:0xf bank_mask:0xf
    s_waitcnt vmcnt(25)
    v_mfma_f32_16x16x32_bf16 v[20:23], v[40:43], v[120:123], v[20:23]
    v_and_b32_dpp v32, v25, v16 row_newbcast:0 row_mask:0xf bank_mask:0xf
    v_and_b32_dpp v33, v25, v17 row_newbcast:0 row_mask:0xf bank_mask:0xf
    v_and_b32_dpp v34, v25, v18 row_newbcast:0 row_mask:0xf bank_mask:0xf
    v_and_b32_dpp v35, v25, v19 row_newbcast:0 row_mask:0xf bank_mask:0xf
    s_waitcnt vmcnt(24)
    v_mfma_f32_16x16x32_bf16 v[20:23], v[44:47], v[124:127], v[20:23]
    v_and_b32_dpp v36, v25, v16 row_newbcast:1 row_mask:0xf bank_mask:0xf
    v_and_b32_dpp v37, v25, v17 row_newbcast:1 row_mask:0xf bank_mask:0xf
    v_and_b32_dpp v38, v25, v18 row_newbcast:1 row_mask:0xf bank_mask:0xf
    v_and_b32_dpp v39, v25, v19 row_newbcast:1 row_mask:0xf bank_mask:0xf
    s_waitcnt vmcnt(23)
    v_mfma_f32_16x16x32_bf16 v[20:23], v[32:35], v[128:131], v[20:23]
    v_and_b32_dpp v40, v25, v16 row_newbcast:2 row_mask:0xf bank_mask:0xf
    v_and_b32_dpp v41, v25, v17 row_newbcast:2 row_mask:0xf bank_mask:0xf
    v_and_b32_dpp v42, v25, v18 row_newbcast:2 row_mask:0xf bank_mask:0xf
    v_and_b32_dpp v43, v25, v19 row_newbcast:2 row_mask:0xf bank_mask:0xf
    s_waitcnt vmcnt(22)
    v_mfma_f32_16x16x32_bf16 v[20:23], v[36:39], v[132:135], v[20:23]
    v_and_b32_dpp v44, v25, v16 row_newbcast:3 row_mask:0xf bank_mask:0xf
    v_and_b32_dpp v45, v25, v17 row_newbcast:3 row_mask:0xf bank_mask:0xf
    v_and_b32_dpp v46, v25, v18 row_newbcast:3 row_mask:0xf bank_mask:0xf
    v_and_b32_dpp v47, v25, v19 row_newbcast:3 row_mask:0xf bank_mask:0xf
    s_waitcnt vmcnt(21)
    v_mfma_f32_16x16x32_bf16 v[20:23], v[40:43], v[136:139], v[20:23]
    v_and_b32_dpp v32, v25, v16 row_newbcast:4 row_mask:0xf bank_mask:0xf
    v_and_b32_dpp v33, v25, v17 row_newbcast:4 row_mask:0xf bank_mask:0xf
    v_and_b32_dpp v34, v25, v18 row_newbcast:4 row_mask:0xf bank_mask:0xf
    v_and_b32_dpp v35, v25, v19 row_newbcast:4 row_mask:0xf bank_mask:0xf
    s_waitcnt vmcnt(20)
    v_mfma_f32_16x16x32_bf16 v[20:23], v[44:47], v[140:143], v[20:23]
    v_and_b32_dpp v36, v25, v16 row_newbcast:5 row_mask:0xf bank_mask:0xf
    v_and_b32_dpp v37, v25, v17 row_newbcast:5 row_mask:0xf bank_mask:0xf
    v_and_b32_dpp v38, v25, v18 row_newbcast:5 row_mask:0xf bank_mask:0xf
    v_and_b32_dpp v39, v25, v19 row_newbcast:5 row_mask:0xf bank_mask:0xf
    s_waitcnt vmcnt(19)
    v_mfma_f32_16x16x32_bf16 v[20:23], v[32:35], v[144:147], v[20:23]
    v_and_b32_dpp v40, v25, v16 row_newbcast:6 row_mask:0xf bank_mask:0xf
    v_and_b32_dpp v41, v25, v17 row_newbcast:6 row_mask:0xf bank_mask:0xf
    v_and_b32_dpp v42, v25, v18 row_newbcast:6 row_mask:0xf bank_mask:0xf
    v_and_b32_dpp v43, v25, v19 row_newbcast:6 row_mask:0xf bank_mask:0xf
    s_waitcnt vmcnt(18)
    v_mfma_f32_16x16x32_bf16 v[20:23], v[36:39], v[148:151], v[20:23]
    v_and_b32_dpp v44, v25, v16 row_newbcast:7 row_mask:0xf bank_mask:0xf
    v_and_b32_dpp v45, v25, v17 row_newbcast:7 row_mask:0xf bank_mask:0xf
    v_and_b32_dpp v46, v25, v18 row_newbcast:7 row_mask:0xf bank_mask:0xf
    v_and_b32_dpp v47, v25, v19 row_newbcast:7 row_mask:0xf bank_mask:0xf
    s_waitcnt vmcnt(17)
    v_mfma_f32_16x16x32_bf16 v[20:23], v[40:43], v[152:155], v[20:23]
    v_and_b32_dpp v32, v25, v16 row_newbcast:8 row_mask:0xf bank_mask:0xf
    v_and_b32_dpp v33, v25, v17 row_newbcast:8 row_mask:0xf bank_mask:0xf
    v_and_b32_dpp v34, v25, v18 row_newbcast:8 row_mask:0xf bank_mask:0xf
    v_and_b32_dpp v35, v25, v19 row_newbcast:8 row_mask:0xf bank_mask:0xf
    s_waitcnt vmcnt(16)
    v_mfma_f32_16x16x32_bf16 v[20:23], v[44:47], v[156:159], v[20:23]
    v_and_b32_dpp v36, v25, v16 row_newbcast:9 row_mask:0xf bank_mask:0xf
    v_and_b32_dpp v37, v25, v17 row_newbcast:9 row_mask:0xf bank_mask:0xf
    v_and_b32_dpp v38, v25, v18 row_newbcast:9 row_mask:0xf bank_mask:0xf
    v_and_b32_dpp v39, v25, v19 row_newbcast:9 row_mask:0xf bank_mask:0xf
    s_waitcnt vmcnt(15)
    v_mfma_f32_16x16x32_bf16 v[20:23], v[32:35], v[160:163], v[20:23]
    v_and_b32_dpp v40, v25, v16 row_newbcast:10 row_mask:0xf bank_mask:0xf
    v_and_b32_dpp v41, v25, v17 row_newbcast:10 row_mask:0xf bank_mask:0xf
    v_and_b32_dpp v42, v25, v18 row_newbcast:10 row_mask:0xf bank_mask:0xf
    v_and_b32_dpp v43, v25, v19 row_newbcast:10 row_mask:0xf bank_mask:0xf
    s_waitcnt vmcnt(14)
    v_mfma_f32_16x16x32_bf16 v[20:23], v[36:39], v[164:167], v[20:23]
    v_and_b32_dpp v44, v25, v16 row_newbcast:11 row_mask:0xf bank_mask:0xf
    v_and_b32_dpp v45, v25, v17 row_newbcast:11 row_mask:0xf bank_mask:0xf
    v_and_b32_dpp v46, v25, v18 row_newbcast:11 row_mask:0xf bank_mask:0xf
    v_and_b32_dpp v47, v25, v19 row_newbcast:11 row_mask:0xf bank_mask:0xf
    s_waitcnt vmcnt(13)
    v_mfma_f32_16x16x32_bf16 v[20:23], v[40:43], v[168:171], v[20:23]
    v_and_b32_dpp v32, v25, v16 row_newbcast:12 row_mask:0xf bank_mask:0xf
    v_and_b32_dpp v33, v25, v17 row_newbcast:12 row_mask:0xf bank_mask:0xf
    v_and_b32_dpp v34, v25, v18 row_newbcast:12 row_mask:0xf bank_mask:0xf
    v_and_b32_dpp v35, v25, v19 row_newbcast:12 row_mask:0xf bank_mask:0xf
    s_waitcnt vmcnt(12)
    v_mfma_f32_16x16x32_bf16 v[20:23], v[44:47], v[172:175], v[20:23]
    v_and_b32_dpp v36, v25, v16 row_newbcast:13 row_mask:0xf bank_mask:0xf
    v_and_b32_dpp v37, v25, v17 row_newbcast:13 row_mask:0xf bank_mask:0xf
    v_and_b32_dpp v38, v25, v18 row_newbcast:13 row_mask:0xf bank_mask:0xf
    v_and_b32_dpp v39, v25, v19 row_newbcast:13 row_mask:0xf bank_mask:0xf
    s_waitcnt vmcnt(11)
    v_mfma_f32_16x16x32_bf16 v[20:23], v[32:35], v[176:179], v[20:23]
    v_and_b32_dpp v40, v25, v16 row_newbcast:14 row_mask:0xf bank_mask:0xf
    v_and_b32_dpp v41, v25, v17 row_newbcast:14 row_mask:0xf bank_mask:0xf
    v_and_b32_dpp v42, v25, v18 row_newbcast:14 row_mask:0xf bank_mask:0xf
    v_and_b32_dpp v43, v25, v19 row_newbcast:14 row_mask:0xf bank_mask:0xf
    s_waitcnt vmcnt(10)
    v_mfma_f32_16x16x32_bf16 v[20:23], v[36:39], v[180:183], v[20:23]
    v_and_b32_dpp v44, v25, v16 row_newbcast:15 row_mask:0xf bank_mask:0xf
    v_and_b32_dpp v45, v25, v17 row_newbcast:15 row_mask:0xf bank_mask:0xf
    v_and_b32_dpp v46, v25, v18 row_newbcast:15 row_mask:0xf bank_mask:0xf
    v_and_b32_dpp v47, v25, v19 row_newbcast:15 row_mask:0xf bank_mask:0xf
    s_waitcnt vmcnt(9)
    v_mfma_f32_16x16x32_bf16 v[20:23], v[40:43], v[184:187], v[20:23]
    v_and_b32_dpp v32, v26, v16 row_newbcast:0 row_mask:0xf bank_mask:0xf
    v_and_b32_dpp v33, v26, v17 row_newbcast:0 row_mask:0xf bank_mask:0xf
    v_and_b32_dpp v34, v26, v18 row_newbcast:0 row_mask:0xf bank_mask:0xf
    v_and_b32_dpp v35, v26, v19 row_newbcast:0 row_mask:0xf bank_mask:0xf
    s_waitcnt vmcnt(8)
    v_mfma_f32_16x16x32_bf16 v[20:23], v[44:47], v[188:191], v[20:23]
    v_and_b32_dpp v36, v26, v16 row_newbcast:1 row_mask:0xf bank_mask:0xf
    v_and_b32_dpp v37, v26, v17 row_newbcast:1 row_mask:0xf bank_mask:0xf
    v_and_b32_dpp v38, v26, v18 row_newbcast:1 row_mask:0xf bank_mask:0xf
    v_and_b32_dpp v39, v26, v19 row_newbcast:1 row_mask:0xf bank_mask:0xf
    s_waitcnt vmcnt(7)
    v_mfma_f32_16x16x32_bf16 v[20:23], v[32:35], v[192:195], v[20:23]
    v_and_b32_dpp v40, v26, v16 row_newbcast:2 row_mask:0xf bank_mask:0xf
    v_and_b32_dpp v41, v26, v17 row_newbcast:2 row_mask:0xf bank_mask:0xf
    v_and_b32_dpp v42, v26, v18 row_newbcast:2 row_mask:0xf bank_mask:0xf
    v_and_b32_dpp v43, v26, v19 row_newbcast:2 row_mask:0xf bank_mask:0xf
    s_waitcnt vmcnt(6)
    v_mfma_f32_16x16x32_bf16 v[20:23], v[36:39], v[196:199], v[20:23]
    v_and_b32_dpp v44, v26, v16 row_newbcast:3 row_mask:0xf bank_mask:0xf
    v_and_b32_dpp v45, v26, v17 row_newbcast:3 row_mask:0xf bank_mask:0xf
    v_and_b32_dpp v46, v26, v18 row_newbcast:3 row_mask:0xf bank_mask:0xf
    v_and_b32_dpp v47, v26, v19 row_newbcast:3 row_mask:0xf bank_mask:0xf
    s_waitcnt vmcnt(5)
    v_mfma_f32_16x16x32_bf16 v[20:23], v[40:43], v[200:203], v[20:23]
    v_and_b32_dpp v32, v26, v16 row_newbcast:4 row_mask:0xf bank_mask:0xf
    v_and_b32_dpp v33, v26, v17 row_newbcast:4 row_mask:0xf bank_mask:0xf
    v_and_b32_dpp v34, v26, v18 row_newbcast:4 row_mask:0xf bank_mask:0xf
    v_and_b32_dpp v35, v26, v19 row_newbcast:4 row_mask:0xf bank_mask:0xf
    s_waitcnt vmcnt(4)
    v_mfma_f32_16x16x32_bf16 v[20:23], v[44:47], v[204:207], v[20:23]
    v_and_b32_dpp v36, v26, v16 row_newbcast:5 row_mask:0xf bank_mask:0xf
    v_and_b32_dpp v37, v26, v17 row_newbcast:5 row_mask:0xf bank_mask:0xf
    v_and_b32_dpp v38, v26, v18 row_newbcast:5 row_mask:0xf bank_mask:0xf
    v_and_b32_dpp v39, v26, v19 row_newbcast:5 row_mask:0xf bank_mask:0xf
    s_waitcnt vmcnt(3)
    v_mfma_f32_16x16x32_bf16 v[20:23], v[32:35], v[208:211], v[20:23]
    v_and_b32_dpp v40, v26, v16 row_newbcast:6 row_mask:0xf bank_mask:0xf
    v_and_b32_dpp v41, v26, v17 row_newbcast:6 row_mask:0xf bank_mask:0xf
    v_and_b32_dpp v42, v26, v18 row_newbcast:6 row_mask:0xf bank_mask:0xf
    v_and_b32_dpp v43, v26, v19 row_newbcast:6 row_mask:0xf bank_mask:0xf
    s_waitcnt vmcnt(2)
    v_mfma_f32_16x16x32_bf16 v[20:23], v[36:39], v[212:215], v[20:23]
    v_and_b32_dpp v44, v26, v16 row_newbcast:7 row_mask:0xf bank_mask:0xf
    v_and_b32_dpp v45, v26, v17 row_newbcast:7 row_mask:0xf bank_mask:0xf
    v_and_b32_dpp v46, v26, v18 row_newbcast:7 row_mask:0xf bank_mask:0xf
    v_and_b32_dpp v47, v26, v19 row_newbcast:7 row_mask:0xf bank_mask:0xf
    s_waitcnt vmcnt(1)
    v_mfma_f32_16x16x32_bf16 v[20:23], v[40:43], v[216:219], v[20:23]
    s_waitcnt vmcnt(0)
    v_mfma_f32_16x16x32_bf16 v[20:23], v[44:47], v[220:223], v[20:23]
    v_lshlrev_b32 v48, 3, v9
    s_cmp_eq_u32 s3, 6
    s_cbranch_scc1 L_hsum
    s_nop 4
    ds_write_b64 v48, v[20:21] offset:4096
    s_waitcnt lgkmcnt(0)
    ds_write_b32 v2, v3 offset:24
    s_branch L_soft
L_hsum:
    s_mov_b32 s64, 0x400000
L_lw_15:
    ds_read_b32 v11, v2 offset:24
    s_sub_u32 s64, s64, 1
    s_cmp_eq_u32 s64, 0
    s_cbranch_scc1 L_lwd_16
    s_waitcnt lgkmcnt(0)
    v_cmp_gt_u32 vcc, 1, v11
    s_cbranch_vccnz L_lw_15
L_lwd_16:
    ds_read_b64 v[24:25], v48 offset:4096
    s_waitcnt lgkmcnt(0)
    v_pk_add_f32 v[20:21], v[20:21], v[24:25]
    v_mov_b32 v23, s34
    buffer_store_dwordx4 v[20:23], v1, s[48:51], s6 offen sc1
    s_branch L_help7
L_hnomod:
    s_load_dword s34, s[30:31], 0
    s_mov_b32 s48, s30
    s_mov_b32 s49, s31
    s_mov_b32 s50, 3933184
    s_mov_b32 s51, 0x20000
    v_and_b32 v48, 1, v9
    v_lshlrev_b32 v48, 4, v48
    v_mov_b32 v49, 0xffff
    v_lshlrev_b32 v48, v48, v49
    v_bfe_u32 v49, v9, 1, 2
    v_bfe_u32 v50, v9, 1, 3
    v_cmp_eq_u32 vcc, 0, v49
    s_nop 1
    v_cndmask_b32 v60, 0, v48, vcc
    v_cmp_eq_u32 vcc, 0, v50
    s_nop 1
    v_cndmask_b32 v16, 0, v48, vcc
    v_cmp_eq_u32 vcc, 1, v49
    s_nop 1
    v_cndmask_b32 v61, 0, v48, vcc
    v_cmp_eq_u32 vcc, 2, v50
    s_nop 1
    v_cndmask_b32 v17, 0, v48, vcc
    v_cmp_eq_u32 vcc, 2, v49
    s_nop 1
    v_cndmask_b32 v62, 0, v48, vcc
    v_cmp_eq_u32 vcc, 4, v50
    s_nop 1
    v_cndmask_b32 v18, 0, v48, vcc
    v_cmp_eq_u32 vcc, 3, v49
    s_nop 1
    v_cndmask_b32 v63, 0, v48, vcc
    v_cmp_eq_u32 vcc, 6, v50
    s_nop 1
    v_cndmask_b32 v19, 0, v48, vcc
    v_and_b32 v48, 15, v9
    v_lshlrev_b32 v48, 6, v48
    v_and_b32 v49, 48, v9
    v_add_u32 v10, v48, v49
    s_waitcnt lgkmcnt(0)
    s_add_u32 s34, s34, 0x01010101
    s_cmp_lg_u32 s3, 7
    s_cbranch_scc1 L_help7
L_soft:
    s_lshl_b32 s6, s32, 13
    s_add_u32 s6, s6, 110592
    s_lshl_b32 s8, s33, 10
    s_add_u32 s8, s8, s6
    s_add_u32 s6, s6, s30
    s_addc_u32 s7, s31, 0
    v_lshlrev_b32 v48, 3, v9
    s_mov_b32 s64, 0x400000
L_lw_17:
    s_sleep 16
    ds_read_b32 v11, v2 offset:0
    s_sub_u32 s64, s64, 1
    s_cmp_eq_u32 s64, 0
    s_cbranch_scc1 L_lwd_18
    s_waitcnt lgkmcnt(0)
    v_cmp_gt_u32 vcc, 120, v11
    s_cbranch_vccnz L_lw_17
L_lwd_18:
    s_mov_b32 s64, 0x400000
L_lw_19:
    s_sleep 4
    ds_read_b32 v11, v2 offset:16
    s_sub_u32 s64, s64, 1
    s_cmp_eq_u32 s64, 0
    s_cbranch_scc1 L_lwd_20
    s_waitcnt lgkmcnt(0)
    v_cmp_gt_u32 vcc, 6, v11
    s_cbranch_vccnz L_lw_19
L_lwd_20:
    s_memrealtime s[10:11]
    ds_read_b128 v[64:67], v1 offset:12288
    ds_read_b128 v[68:71], v1 offset:13312
    ds_read_b128 v[72:75], v1 offset:14336
    ds_read_b128 v[76:79], v1 offset:15360
    ds_read_b128 v[80:83], v1 offset:16384
    ds_read_b128 v[84:87], v1 offset:17408
    ds_read_b128 v[88:91], v1 offset:18432
    ds_read_b128 v[92:95], v1 offset:19456
    s_waitcnt lgkmcnt(0)
    v_cvt_pk_bf16_f32 v20, v92, v93
    v_cvt_pk_bf16_f32 v21, v94, v95
    s_lshl_b64 exec, -1, 32
    buffer_store_dwordx2 v[20:21], v48, s[48:51], s8 offen sc1
    s_mov_b64 exec, -1
    v_max3_f32 v24, v64, v65, v66
    v_max3_f32 v25, v67, v68, v69
    v_max3_f32 v24, v24, v70, v71
    v_max3_f32 v25, v25, v72, v73
    v_max3_f32 v24, v24, v74, v75
    v_max3_f32 v25, v25, v76, v77
    v_max3_f32 v24, v24, v78, v79
    v_max3_f32 v25, v25, v80, v81
    v_max3_f32 v24, v24, v82, v83
    v_max3_f32 v25, v25, v84, v85
    v_max3_f32 v24, v24, v86, v87
    v_max3_f32 v25, v25, v88, v89
    v_max3_f32 v24, v24, v90, v91
    v_max3_f32 v25, v25, v92, v93
    v_max3_f32 v24, v24, v94, v95
    v_max_f32 v24, v24, v25
    s_nop 1
    v_max_f32_dpp v24, v24, v24 quad_perm:[1,0,3,2] row_mask:0xf bank_mask:0xf
    s_nop 1
    v_max_f32_dpp v24, v24, v24 quad_perm:[2,3,0,1] row_mask:0xf bank_mask:0xf
    s_nop 1
    v_max_f32_dpp v24, v24, v24 row_ror:4 row_mask:0xf bank_mask:0xf
    s_nop 1
    v_max_f32_dpp v24, v24, v24 row_ror:8 row_mask:0xf bank_mask:0xf
    v_mov_b32 v25, v24
    s_nop 1
    v_permlane16_swap_b32 v24, v25
    v_max_f32 v24, v24, v25
    v_mov_b32 v25, v24
    s_nop 1
    v_permlane32_swap_b32 v24, v25
    v_max_f32 v24, v24, v25
    v_mul_f32 v24, s62, v24
    v_fma_f32 v64, v64, s62, -v24
    v_fma_f32 v65, v65, s62, -v24
    v_fma_f32 v66, v66, s62, -v24
    v_fma_f32 v67, v67, s62, -v24
    v_fma_f32 v68, v68, s62, -v24
    v_fma_f32 v69, v69, s62, -v24
    v_fma_f32 v70, v70, s62, -v24
    v_fma_f32 v71, v71, s62, -v24
    v_fma_f32 v72, v72, s62, -v24
    v_fma_f32 v73, v73, s62, -v24
    v_fma_f32 v74, v74, s62, -v24
    v_fma_f32 v75, v75, s62, -v24
    v_fma_f32 v76, v76, s62, -v24
    v_fma_f32 v77, v77, s62, -v24
    v_fma_f32 v78, v78, s62, -v24
    v_fma_f32 v79, v79, s62, -v24
    v_fma_f32 v80, v80, s62, -v24
    v_fma_f32 v81, v81, s62, -v24
    v_fma_f32 v82, v82, s62, -v24
    v_fma_f32 v83, v83, s62, -v24
    v_fma_f32 v84, v84, s62, -v24
    v_fma_f32 v85, v85, s62, -v24
    v_fma_f32 v86, v86, s62, -v24
    v_fma_f32 v87, v87, s62, -v24
    v_fma_f32 v88, v88, s62, -v24
    v_fma_f32 v89, v89, s62, -v24
    v_fma_f32 v90, v90, s62, -v24
    v_fma_f32 v91, v91, s62, -v24
    v_fma_f32 v92, v92, s62, -v24
    v_fma_f32 v93, v93, s62, -v24
    v_fma_f32 v94, v94, s62, -v24
    v_fma_f32 v95, v95, s62, -v24
    v_exp_f32 v64, v64
    v_exp_f32 v65, v65
    v_exp_f32 v66, v66
    v_exp_f32 v67, v67
    v_exp_f32 v68, v68
    v_exp_f32 v69, v69
    v_exp_f32 v70, v70
    v_exp_f32 v71, v71
    v_exp_f32 v72, v72
    v_exp_f32 v73, v73
    v_exp_f32 v74, v74
    v_exp_f32 v75, v75
    v_exp_f32 v76, v76
    v_exp_f32 v77, v77
    v_exp_f32 v78, v78
    v_exp_f32 v79, v79
    v_exp_f32 v80, v80
    v_exp_f32 v81, v81
    v_exp_f32 v82, v82
    v_exp_f32 v83, v83
    v_exp_f32 v84, v84
    v_exp_f32 v85, v85
    v_exp_f32 v86, v86
    v_exp_f32 v87, v87
    v_exp_f32 v88, v88
    v_exp_f32 v89, v89
    v_exp_f32 v90, v90
    v_exp_f32 v91, v91
    v_exp_f32 v92, v92
    v_exp_f32 v93, v93
    v_exp_f32 v94, v94
    v_exp_f32 v95, v95
    v_pk_add_f32 v[26:27], v[64:65], v[66:67]
    v_pk_add_f32 v[26:27], v[26:27], v[68:69]
    v_pk_add_f32 v[26:27], v[26:27], v[70:71]
    v_pk_add_f32 v[26:27], v[26:27], v[72:73]
    v_pk_add_f32 v[26:27], v[26:27], v[74:75]
    v_pk_add_f32 v[26:27], v[26:27], v[76:77]
    v_pk_add_f32 v[26:27], v[26:27], v[78:79]
    v_pk_add_f32 v[26:27], v[26:27], v[80:81]
    v_pk_add_f32 v[26:27], v[26:27], v[82:83]
    v_pk_add_f32 v[26:27], v[26:27], v[84:85]
    v_pk_add_f32 v[26:27], v[26:27], v[86:87]
    v_pk_add_f32 v[26:27], v[26:27], v[88:89]
    v_pk_add_f32 v[26:27], v[26:27], v[90:91]
    v_pk_add_f32 v[26:27], v[26:27], v[92:93]
    v_pk_add_f32 v[26:27], v[26:27], v[94:95]
    v_add_f32 v26, v26, v27
    s_nop 1
    v_add_f32_dpp v26, v26, v26 quad_perm:[1,0,3,2] row_mask:0xf bank_mask:0xf
    s_nop 1
    v_add_f32_dpp v26, v26, v26 quad_perm:[2,3,0,1] row_mask:0xf bank_mask:0xf
    s_nop 1
    v_add_f32_dpp v26, v26, v26 row_ror:4 row_mask:0xf bank_mask:0xf
    s_nop 1
    v_add_f32_dpp v26, v26, v26 row_ror:8 row_mask:0xf bank_mask:0xf
    v_mov_b32 v25, v26
    s_nop 1
    v_permlane16_swap_b32 v26, v25
    v_add_f32 v26, v26, v25
    v_mov_b32 v25, v26
    s_nop 1
    v_permlane32_swap_b32 v26, v25
    v_add_f32 v26, v26, v25
    v_log_f32 v22, v26
    s_nop 0
    v_add_f32 v12, v22, v24
    v_mov_b32 v13, s34
    v_mov_b32 v14, s10
    s_waitcnt vmcnt(0)
    s_mov_b64 exec, 1
    buffer_store_dwordx4 v[12:15], v2, s[48:51], s8 offen offset:512 sc1
    s_mov_b64 exec, -1
    s_mov_b32 s64, 0x40000
L_lam:
    s_load_dwordx2 s[40:41], s[6:7], 512 glc
    s_load_dwordx2 s[42:43], s[6:7], 1536 glc
    s_load_dwordx2 s[44:45], s[6:7], 2560 glc
    s_load_dwordx2 s[46:47], s[6:7], 3584 glc
    s_load_dwordx2 s[52:53], s[6:7], 4608 glc
    s_load_dwordx2 s[54:55], s[6:7], 5632 glc
    s_load_dwordx2 s[56:57], s[6:7], 6656 glc
    s_load_dwordx2 s[58:59], s[6:7], 7680 glc
    s_sub_u32 s64, s64, 1
    s_cmp_eq_u32 s64, 0
    s_cbranch_scc1 L_lamd
    s_waitcnt lgkmcnt(0)
    s_cmp_lg_u32 s41, s34
    s_cbranch_scc1 L_lam
    s_cmp_lg_u32 s43, s34
    s_cbranch_scc1 L_lam
    s_cmp_lg_u32 s45, s34
    s_cbranch_scc1 L_lam
    s_cmp_lg_u32 s47, s34
    s_cbranch_scc1 L_lam
    s_cmp_lg_u32 s53, s34
    s_cbranch_scc1 L_lam
    s_cmp_lg_u32 s55, s34
    s_cbranch_scc1 L_lam
    s_cmp_lg_u32 s57, s34
    s_cbranch_scc1 L_lam
    s_cmp_lg_u32 s59, s34
    s_cbranch_scc1 L_lam
L_lamd:
    s_waitcnt lgkmcnt(0)
    v_mov_b32 v96, s40
    v_mov_b32 v97, s42
    v_mov_b32 v98, s44
    v_mov_b32 v99, s46
    v_mov_b32 v100, s52
    v_mov_b32 v101, s54
    v_mov_b32 v102, s56
    v_mov_b32 v103, s58
    s_load_dword s41, s[6:7], 520 glc
    s_load_dword s43, s[6:7], 1544 glc
    s_load_dword s45, s[6:7], 2568 glc
    s_load_dword s47, s[6:7], 3592 glc
    s_load_dword s53, s[6:7], 4616 glc
    s_load_dword s55, s[6:7], 5640 glc
    s_load_dword s57, s[6:7], 6664 glc
    s_load_dword s59, s[6:7], 7688 glc
    v_max3_f32 v28, v96, v97, v98
    v_max3_f32 v28, v28, v99, v100
    v_max3_f32 v28, v28, v101, v102
    v_max_f32 v28, v28, v103
    v_sub_f32 v96, v96, v28
    v_sub_f32 v97, v97, v28
    v_sub_f32 v98, v98, v28
    v_sub_f32 v99, v99, v28
    v_sub_f32 v100, v100, v28
    v_sub_f32 v101, v101, v28
    v_sub_f32 v102, v102, v28
    v_sub_f32 v103, v103, v28
    v_exp_f32 v96, v96
    v_exp_f32 v97, v97
    v_exp_f32 v98, v98
    v_exp_f32 v99, v99
    v_exp_f32 v100, v100
    v_exp_f32 v101, v101
    v_exp_f32 v102, v102
    v_exp_f32 v103, v103
    v_add_f32 v96, v96, v97
    v_add_f32 v96, v96, v98
    v_add_f32 v96, v96, v99
    v_add_f32 v96, v96, v100
    v_add_f32 v96, v96, v101
    v_add_f32 v96, v96, v102
    v_add_f32 v96, v96, v103
    v_log_f32 v96, v96
    s_nop 0
    v_add_f32 v28, v28, v96
    v_sub_f32 v24, v24, v28
    v_exp_f32 v24, v24
    ds_write_b32 v2, v28 offset:32
    v_mul_f32 v64, v64, v24
    v_mul_f32 v65, v65, v24
    v_mul_f32 v66, v66, v24
    v_mul_f32 v67, v67, v24
    v_mul_f32 v68, v68, v24
    v_mul_f32 v69, v69, v24
    v_mul_f32 v70, v70, v24
    v_mul_f32 v71, v71, v24
    v_mul_f32 v72, v72, v24
    v_mul_f32 v73, v73, v24
    v_mul_f32 v74, v74, v24
    v_mul_f32 v75, v75, v24
    v_mul_f32 v76, v76, v24
    v_mul_f32 v77, v77, v24
    v_mul_f32 v78, v78, v24
    v_mul_f32 v79, v79, v24
    v_mul_f32 v80, v80, v24
    v_mul_f32 v81, v81, v24
    v_mul_f32 v82, v82, v24
    v_mul_f32 v83, v83, v24
    v_mul_f32 v84, v84, v24
    v_mul_f32 v85, v85, v24
    v_mul_f32 v86, v86, v24
    v_mul_f32 v87, v87, v24
    v_mul_f32 v88, v88, v24
    v_mul_f32 v89, v89, v24
    v_mul_f32 v90, v90, v24
    v_mul_f32 v91, v91, v24
    v_mul_f32 v92, v92, v24
    v_mul_f32 v93, v93, v24
    v_mul_f32 v94, v94, v24
    v_mul_f32 v95, v95, v24
    v_cvt_pk_bf16_f32 v64, v64, v64
    v_cvt_pk_bf16_f32 v65, v65, v65
    v_cvt_pk_bf16_f32 v66, v66, v66
    v_cvt_pk_bf16_f32 v67, v67, v67
    v_cvt_pk_bf16_f32 v68, v68, v68
    v_cvt_pk_bf16_f32 v69, v69, v69
    v_cvt_pk_bf16_f32 v70, v70, v70
    v_cvt_pk_bf16_f32 v71, v71, v71
    v_cvt_pk_bf16_f32 v72, v72, v72
    v_cvt_pk_bf16_f32 v73, v73, v73
    v_cvt_pk_bf16_f32 v74, v74, v74
    v_cvt_pk_bf16_f32 v75, v75, v75
    v_cvt_pk_bf16_f32 v76, v76, v76
    v_cvt_pk_bf16_f32 v77, v77, v77
    v_cvt_pk_bf16_f32 v78, v78, v78
    v_cvt_pk_bf16_f32 v79, v79, v79
    v_cvt_pk_bf16_f32 v80, v80, v80
    v_cvt_pk_bf16_f32 v81, v81, v81
    v_cvt_pk_bf16_f32 v82, v82, v82
    v_cvt_pk_bf16_f32 v83, v83, v83
    v_cvt_pk_bf16_f32 v84, v84, v84
    v_cvt_pk_bf16_f32 v85, v85, v85
    v_cvt_pk_bf16_f32 v86, v86, v86
    v_cvt_pk_bf16_f32 v87, v87, v87
    v_cvt_pk_bf16_f32 v88, v88, v88
    v_cvt_pk_bf16_f32 v89, v89, v89
    v_cvt_pk_bf16_f32 v90, v90, v90
    v_cvt_pk_bf16_f32 v91, v91, v91
    v_cvt_pk_bf16_f32 v92, v92, v92
    v_cvt_pk_bf16_f32 v93, v93, v93
    v_cvt_pk_bf16_f32 v94, v94, v94
    v_cvt_pk_bf16_f32 v95, v95, v95
    ds_write_b128 v1, v[64:67] offset:12288
    ds_write_b128 v1, v[68:71] offset:13312
    ds_write_b128 v1, v[72:75] offset:14336
    ds_write_b128 v1, v[76:79] offset:15360
    ds_write_b128 v1, v[80:83] offset:16384
    ds_write_b128 v1, v[84:87] offset:17408
    ds_write_b128 v1, v[88:91] offset:18432
    ds_write_b128 v1, v[92:95] offset:19456
    s_waitcnt lgkmcnt(0)
    ds_write_b32 v2, v3 offset:12
    s_mov_b32 s9, 0
    s_sub_u32 s68, s10, s41
    s_add_u32 s9, s9, s68
    s_sub_u32 s68, s10, s43
    s_add_u32 s9, s9, s68
    s_sub_u32 s68, s10, s45
    s_add_u32 s9, s9, s68
    s_sub_u32 s68, s10, s47
    s_add_u32 s9, s9, s68
    s_sub_u32 s68, s10, s53
    s_add_u32 s9, s9, s68
    s_sub_u32 s68, s10, s55
    s_add_u32 s9, s9, s68
    s_sub_u32 s68, s10, s57
    s_add_u32 s9, s9, s68
    s_sub_u32 s68, s10, s59
    s_add_u32 s9, s9, s68
    s_ashr_i32 s9, s9, 3
    s_sub_i32 s9, s9, 20
    s_max_i32 s9, s9, 0
    s_min_i32 s9, s9, 1000
    s_mul_i32 s9, s9, 26
    s_lshr_b32 s9, s9, 8
    s_min_u32 s9, s9, 20
    s_add_u32 s9, s9, 1
    v_mov_b32 v48, s9
    ds_write_b32 v2, v48 offset:28
    s_setprio 0
    s_waitcnt lgkmcnt(0)
    s_branch L_join
L_help7:
    s_bitcmp1_b32 s35, 2
    s_cselect_b32 s37, 6, 10
    s_cmp_lt_u32 s35, 24
    s_cselect_b32 s37, 0, s37
    s_cmp_lt_u32 s35, 22
    s_cselect_b32 s37, 3, s37
    s_cmp_lt_u32 s35, 17
    s_cselect_b32 s37, 4, s37
    s_cmp_lt_u32 s35, 10
    s_cselect_b32 s37, 8, s37
    s_cmp_lt_u32 s35, 5
    s_cselect_b32 s37, 0, s37
    s_cmp_eq_u32 s37, 0
    s_cbranch_scc1 L_xkd
    s_load_dwordx2 s[6:7], s[0:1], 8
    s_mul_i32 s61, s32, 304
    s_lshl_b32 s68, s33, 7
    s_add_u32 s61, s61, s68
    s_lshl_b32 s68, s32, 22
    v_and_b32 v6, 60, v9
    v_and_b32 v48, 15, v9
    v_lshlrev_b32 v48, 4, v48
    s_waitcnt lgkmcnt(0)
    s_add_u32 s40, s6, s68
    s_addc_u32 s41, s7, 0
    s_mov_b32 s42, 0x400000
    s_mov_b32 s43, 0x20000
    s_mov_b32 s64, 0x400000
L_lw_21:
    s_sleep 16
    ds_read_b32 v11, v2 offset:8
    s_sub_u32 s64, s64, 1
    s_cmp_eq_u32 s64, 0
    s_cbranch_scc1 L_lwd_22
    s_waitcnt lgkmcnt(0)
    v_cmp_gt_u32 vcc, 1, v11
    s_cbranch_vccnz L_lw_21
L_lwd_22:
    ds_read_b128 v[12:15], v48 offset:256
L_xk:
    s_mov_b64 exec, 1
    ds_add_rtn_u32 v4, v2, v3 offset:0
    s_mov_b64 exec, -1
    s_waitcnt lgkmcnt(0)
    v_readfirstlane_b32 s66, v4
    s_cmp_ge_u32 s66, 128
    s_cbranch_scc1 L_xkd
    s_add_u32 s69, s66, s61
    s_and_b32 s69, s69, 1023
    s_lshl_b32 s69, s69, 12
    v_add_u32 v5, s69, v1
    buffer_load_dwordx4 v[64:67], v5, s[40:43], 0 offen offset:0 nt
    buffer_load_dwordx4 v[68:71], v5, s[40:43], 0 offen offset:1024 nt
    buffer_load_dwordx4 v[72:75], v5, s[40:43], 0 offen offset:2048 nt
    buffer_load_dwordx4 v[76:79], v5, s[40:43], 0 offen offset:3072 nt
    s_lshl_b32 s68, s66, 6
    v_add_u32 v31, s68, v6
    s_waitcnt vmcnt(0)
    v_dot2_f32_bf16 v24, v64, v12, 0
    v_dot2_f32_bf16 v25, v68, v12, 0
    v_dot2_f32_bf16 v26, v72, v12, 0
    v_dot2_f32_bf16 v27, v76, v12, 0
    v_dot2c_f32_bf16 v24, v65, v13
    v_dot2c_f32_bf16 v25, v69, v13
    v_dot2c_f32_bf16 v26, v73, v13
    v_dot2c_f32_bf16 v27, v77, v13
    v_dot2c_f32_bf16 v24, v66, v14
    v_dot2c_f32_bf16 v25, v70, v14
    v_dot2c_f32_bf16 v26, v74, v14
    v_dot2c_f32_bf16 v27, v78, v14
    v_dot2c_f32_bf16 v24, v67, v15
    v_dot2c_f32_bf16 v25, v71, v15
    v_dot2c_f32_bf16 v26, v75, v15
    v_dot2c_f32_bf16 v27, v79, v15
    v_add_f32_dpp v28, v24, v24 row_ror:8 row_mask:0xf bank_mask:0x3
    s_nop 0
    v_add_f32_dpp v29, v26, v26 row_ror:8 row_mask:0xf bank_mask:0x3
    v_add_f32_dpp v28, v25, v25 row_ror:8 row_mask:0xf bank_mask:0xc
    s_nop 0
    v_add_f32_dpp v29, v27, v27 row_ror:8 row_mask:0xf bank_mask:0xc
    v_add_f32_dpp v30, v28, v28 row_shl:4 row_mask:0xf bank_mask:0x5
    s_nop 1
    v_add_f32_dpp v30, v29, v29 row_shr:4 row_mask:0xf bank_mask:0xa
    s_nop 1
    v_add_f32_dpp v30, v30, v30 quad_perm:[1,0,3,2] row_mask:0xf bank_mask:0xf
    s_nop 1
    v_add_f32_dpp v30, v30, v30 quad_perm:[2,3,0,1] row_mask:0xf bank_mask:0xf
    v_cvt_pk_bf16_f32 v30, v30, v30
    v_and_b32 v30, 0xffff0000, v30
    v_mul_f32 v30, s63, v30
    v_cvt_pk_bf16_f32 v30, v30, v30
    v_and_b32 v30, 0xffff0000, v30
    ds_write_b32 v31, v30 offset:12288
    s_sub_u32 s37, s37, 1
    s_cmp_lg_u32 s37, 0
    s_cbranch_scc1 L_xk
L_xkd:
    s_waitcnt lgkmcnt(0)
    s_mov_b64 exec, 1
    ds_add_u32 v2, v3 offset:16
    s_mov_b64 exec, -1
    s_waitcnt lgkmcnt(0)
    s_cmp_lg_u32 s35, 22
    s_cbranch_scc1 L_nprb
    s_lshl_b32 s6, s36, 14
    s_add_u32 s6, s6, 3801088
    s_add_u32 s6, s6, s30
    s_addc_u32 s7, s31, 0
    s_mov_b32 s8, -1
    s_mov_b32 s9, -1
    s_mov_b32 s37, 22
L_prb:
    s_memtime s[40:41]
    s_waitcnt lgkmcnt(0)
    s_load_dword s44, s[6:7], 0 glc
    s_waitcnt lgkmcnt(0)
    s_memtime s[42:43]
    s_waitcnt lgkmcnt(0)
    s_sub_u32 s42, s42, s40
    s_min_u32 s8, s8, s42
    s_memtime s[40:41]
    s_waitcnt lgkmcnt(0)
    s_load_dword s44, s[6:7], 8192 glc
    s_waitcnt lgkmcnt(0)
    s_memtime s[42:43]
    s_waitcnt lgkmcnt(0)
    s_sub_u32 s42, s42, s40
    s_min_u32 s9, s9, s42
    s_sub_u32 s37, s37, 1
    s_cmp_lg_u32 s37, 0
    s_cbranch_scc1 L_prb
    s_cmp_lt_u32 s9, s8
    s_cselect_b32 s68, 1, 0
    v_mov_b32 v20, s68
    v_mov_b32 v21, s8
    v_mov_b32 v22, s9
    s_lshl_b32 s68, s36, 7
    s_add_u32 s68, s68, 3932160
    s_mov_b64 exec, 1
    v_mov_b32 v23, s34
    buffer_store_dwordx4 v[20:23], v2, s[48:51], s68 offen sc1
    s_mov_b64 exec, -1
L_nprb:
    s_load_dwordx2 s[6:7], s[0:1], 16
    s_mul_i32 s61, s32, 304
    s_lshl_b32 s68, s33, 7
    s_add_u32 s61, s61, s68
    s_lshl_b32 s68, s32, 22
    v_and_b32 v6, 60, v9
    v_mov_b32 v20, 0
    v_mov_b32 v21, 0
    v_mov_b32 v22, 0
    v_mov_b32 v23, 0
    s_waitcnt lgkmcnt(0)
    s_add_u32 s44, s6, s68
    s_addc_u32 s45, s7, 0
    s_mov_b32 s46, 0x400000
    s_mov_b32 s47, 0x20000
    s_mov_b32 s64, 0x400000
L_lw_23:
    s_sleep 16
    ds_read_b32 v11, v2 offset:28
    s_sub_u32 s64, s64, 1
    s_cmp_eq_u32 s64, 0
    s_cbranch_scc1 L_lwd_24
    s_waitcnt lgkmcnt(0)
    v_cmp_gt_u32 vcc, 1, v11
    s_cbranch_vccnz L_lw_23
L_lwd_24:
    s_waitcnt lgkmcnt(0)
    v_readfirstlane_b32 s37, v11
L_xv:
    s_cmp_le_u32 s37, 1
    s_cbranch_scc1 L_xvd
    s_mov_b64 exec, 1
    ds_add_rtn_u32 v4, v2, v3 offset:4
    s_mov_b64 exec, -1
    s_waitcnt lgkmcnt(0)
    v_readfirstlane_b32 s66, v4
    s_cmp_ge_u32 s66, 120
    s_cbranch_scc1 L_xvd
    s_add_u32 s69, s66, s61
    s_and_b32 s69, s69, 1023
    s_lshl_b32 s69, s69, 12
    v_add_u32 v5, s69, v1
    buffer_load_dwordx4 v[64:67], v5, s[44:47], 0 offen offset:0 nt
    buffer_load_dwordx4 v[68:71], v5, s[44:47], 0 offen offset:1024 nt
    buffer_load_dwordx4 v[72:75], v5, s[44:47], 0 offen offset:2048 nt
    buffer_load_dwordx4 v[76:79], v5, s[44:47], 0 offen offset:3072 nt
    s_lshl_b32 s68, s66, 6
    v_add_u32 v31, s68, v6
    ds_read_b32 v31, v31 offset:12288
    s_waitcnt lgkmcnt(0)
    v_and_b32_dpp v32, v31, v16 row_newbcast:0 row_mask:0xf bank_mask:0xf
    v_and_b32_dpp v33, v31, v17 row_newbcast:0 row_mask:0xf bank_mask:0xf
    v_and_b32_dpp v34, v31, v18 row_newbcast:0 row_mask:0xf bank_mask:0xf
    v_and_b32_dpp v35, v31, v19 row_newbcast:0 row_mask:0xf bank_mask:0xf
    v_and_b32_dpp v36, v31, v16 row_newbcast:8 row_mask:0xf bank_mask:0xf
    v_and_b32_dpp v37, v31, v17 row_newbcast:8 row_mask:0xf bank_mask:0xf
    v_and_b32_dpp v38, v31, v18 row_newbcast:8 row_mask:0xf bank_mask:0xf
    v_and_b32_dpp v39, v31, v19 row_newbcast:8 row_mask:0xf bank_mask:0xf
    v_and_b32_dpp v40, v31, v16 row_newbcast:4 row_mask:0xf bank_mask:0xf
    v_and_b32_dpp v41, v31, v17 row_newbcast:4 row_mask:0xf bank_mask:0xf
    v_and_b32_dpp v42, v31, v18 row_newbcast:4 row_mask:0xf bank_mask:0xf
    v_and_b32_dpp v43, v31, v19 row_newbcast:4 row_mask:0xf bank_mask:0xf
    v_and_b32_dpp v44, v31, v16 row_newbcast:12 row_mask:0xf bank_mask:0xf
    v_and_b32_dpp v45, v31, v17 row_newbcast:12 row_mask:0xf bank_mask:0xf
    v_and_b32_dpp v46, v31, v18 row_newbcast:12 row_mask:0xf bank_mask:0xf
    v_and_b32_dpp v47, v31, v19 row_newbcast:12 row_mask:0xf bank_mask:0xf
    s_waitcnt vmcnt(0)
    v_mfma_f32_16x16x32_bf16 v[20:23], v[32:35], v[64:67], v[20:23]
    v_mfma_f32_16x16x32_bf16 v[20:23], v[36:39], v[68:71], v[20:23]
    v_mfma_f32_16x16x32_bf16 v[20:23], v[40:43], v[72:75], v[20:23]
    v_mfma_f32_16x16x32_bf16 v[20:23], v[44:47], v[76:79], v[20:23]
    s_sub_u32 s37, s37, 1
    s_branch L_xv
L_xvd:
    v_lshrrev_b32 v48, 1, v10
    s_nop 2
    ds_write_b64 v48, v[20:21] offset:3584
    s_waitcnt lgkmcnt(0)
    s_branch L_join
L_ctrl0:
    s_setprio 3
    v_mov_b32 v52, 85
    v_mov_b32 v53, 80
    v_mov_b32 v54, 0
    v_mov_b32 v55, 0
    ds_write_b128 v2, v[52:55] offset:0
    ds_write_b64 v2, v[54:55] offset:16
    ds_write_b64 v2, v[54:55] offset:24
    s_waitcnt lgkmcnt(0)
    s_barrier
    s_mov_b32 s39, 0
    s_cmp_ge_u32 s35, 24
    s_cbranch_scc1 L_ctrl_q
    s_sub_u32 s38, s35, 17
    s_cmp_ge_u32 s38, 5
    s_cbranch_scc1 L_ctrl_none
    s_lshl_b32 s38, s38, 3
    s_add_u32 s38, s38, s36
    s_lshl_b32 s6, s38, 10
    s_add_u32 s6, s6, 4096
    s_and_b32 s39, s38, 3
    s_lshr_b32 s38, s38, 2
    s_mov_b32 s52, s24
    s_mov_b32 s53, s25
    s_mov_b32 s54, 4915200
    s_mov_b32 s55, 0x20000
    s_mov_b32 s56, s22
    s_mov_b32 s57, s23
    s_mov_b32 s58, 1280
    s_mov_b32 s59, 0x20000
    v_lshrrev_b32 v48, 4, v9
    v_mul_u32_u24 v48, 40, v48
    v_and_b32 v49, 15, v9
    v_add_u32 v50, v48, v49
    v_lshlrev_b32 v50, 1, v50
    v_and_b32 v51, 7, v9
    v_add_u32 v51, v48, v51
    v_lshlrev_b32 v51, 1, v51
    s_mul_i32 s69, s39, 320
    buffer_load_ushort v24, v50, s[56:59], s69 offen
    buffer_load_ushort v25, v50, s[56:59], s69 offen offset:32
    buffer_load_ushort v26, v51, s[56:59], s69 offen offset:64
    v_mul_u32_u24 v48, 7680, v48
    v_lshl_add_u32 v48, v49, 4, v48
    s_mul_i32 s69, s39, 1228800
    s_lshl_b32 s68, s38, 8
    s_add_u32 s68, s69, s68
    buffer_load_dwordx4 v[64:67], v48, s[52:55], s68 offen nt
    s_add_u32 s68, s68, 7680
    buffer_load_dwordx4 v[68:71], v48, s[52:55], s68 offen nt
    s_add_u32 s68, s68, 7680
    buffer_load_dwordx4 v[72:75], v48, s[52:55], s68 offen nt
    s_add_u32 s68, s68, 7680
    buffer_load_dwordx4 v[76:79], v48, s[52:55], s68 offen nt
    s_add_u32 s68, s68, 7680
    buffer_load_dwordx4 v[80:83], v48, s[52:55], s68 offen nt
    s_add_u32 s68, s68, 7680
    buffer_load_dwordx4 v[84:87], v48, s[52:55], s68 offen nt
    s_add_u32 s68, s68, 7680
    buffer_load_dwordx4 v[88:91], v48, s[52:55], s68 offen nt
    s_add_u32 s68, s68, 7680
    buffer_load_dwordx4 v[92:95], v48, s[52:55], s68 offen nt
    s_add_u32 s68, s68, 7680
    buffer_load_dwordx4 v[96:99], v48, s[52:55], s68 offen nt
    s_add_u32 s68, s68, 7680
    buffer_load_dwordx4 v[100:103], v48, s[52:55], s68 offen nt
    s_add_u32 s68, s68, 7680
    buffer_load_dwordx4 v[104:107], v48, s[52:55], s68 offen nt
    s_add_u32 s68, s68, 7680
    buffer_load_dwordx4 v[108:111], v48, s[52:55], s68 offen nt
    s_add_u32 s68, s68, 7680
    buffer_load_dwordx4 v[112:115], v48, s[52:55], s68 offen nt
    s_add_u32 s68, s68, 7680
    buffer_load_dwordx4 v[116:119], v48, s[52:55], s68 offen nt
    s_add_u32 s68, s68, 7680
    buffer_load_dwordx4 v[120:123], v48, s[52:55], s68 offen nt
    s_add_u32 s68, s68, 7680
    buffer_load_dwordx4 v[124:127], v48, s[52:55], s68 offen nt
    s_add_u32 s68, s68, 7680
    buffer_load_dwordx4 v[128:131], v48, s[52:55], s68 offen nt
    s_add_u32 s68, s68, 7680
    buffer_load_dwordx4 v[132:135], v48, s[52:55], s68 offen nt
    s_add_u32 s68, s68, 7680
    buffer_load_dwordx4 v[136:139], v48, s[52:55], s68 offen nt
    s_add_u32 s68, s68, 7680
    buffer_load_dwordx4 v[140:143], v48, s[52:55], s68 offen nt
    s_add_u32 s68, s68, 7680
    buffer_load_dwordx4 v[144:147], v48, s[52:55], s68 offen nt
    s_add_u32 s68, s68, 7680
    buffer_load_dwordx4 v[148:151], v48, s[52:55], s68 offen nt
    s_add_u32 s68, s68, 7680
    buffer_load_dwordx4 v[152:155], v48, s[52:55], s68 offen nt
    s_add_u32 s68, s68, 7680
    buffer_load_dwordx4 v[156:159], v48, s[52:55], s68 offen nt
    s_add_u32 s68, s68, 7680
    buffer_load_dwordx4 v[160:163], v48, s[52:55], s68 offen nt
    s_add_u32 s68, s68, 7680
    buffer_load_dwordx4 v[164:167], v48, s[52:55], s68 offen nt
    s_add_u32 s68, s68, 7680
    buffer_load_dwordx4 v[168:171], v48, s[52:55], s68 offen nt
    s_add_u32 s68, s68, 7680
    buffer_load_dwordx4 v[172:175], v48, s[52:55], s68 offen nt
    s_add_u32 s68, s68, 7680
    buffer_load_dwordx4 v[176:179], v48, s[52:55], s68 offen nt
    s_add_u32 s68, s68, 7680
    buffer_load_dwordx4 v[180:183], v48, s[52:55], s68 offen nt
    s_add_u32 s68, s68, 7680
    buffer_load_dwordx4 v[184:187], v48, s[52:55], s68 offen nt
    s_add_u32 s68, s68, 7680
    buffer_load_dwordx4 v[188:191], v48, s[52:55], s68 offen nt
    s_add_u32 s68, s68, 7680
    buffer_load_dwordx4 v[192:195], v48, s[52:55], s68 offen nt
    s_add_u32 s68, s68, 7680
    buffer_load_dwordx4 v[196:199], v48, s[52:55], s68 offen nt
    s_add_u32 s68, s68, 7680
    buffer_load_dwordx4 v[200:203], v48, s[52:55], s68 offen nt
    s_add_u32 s68, s68, 7680
    buffer_load_dwordx4 v[204:207], v48, s[52:55], s68 offen nt
    s_add_u32 s68, s68, 7680
    buffer_load_dwordx4 v[208:211], v48, s[52:55], s68 offen nt
    s_add_u32 s68, s68, 7680
    buffer_load_dwordx4 v[212:215], v48, s[52:55], s68 offen nt
    s_add_u32 s68, s68, 7680
    buffer_load_dwordx4 v[216:219], v48, s[52:55], s68 offen nt
    s_add_u32 s68, s68, 7680
    buffer_load_dwordx4 v[220:223], v48, s[52:55], s68 offen nt
    s_load_dword s34, s[30:31], 0
    s_mov_b32 s48, s30
    s_mov_b32 s49, s31
    s_mov_b32 s50, 3933184
    s_mov_b32 s51, 0x20000
    v_and_b32 v48, 1, v9
    v_lshlrev_b32 v48, 4, v48
    v_mov_b32 v49, 0xffff
    v_lshlrev_b32 v48, v48, v49
    v_bfe_u32 v49, v9, 1, 2
    v_bfe_u32 v50, v9, 1, 3
    v_cmp_eq_u32 vcc, 0, v49
    s_nop 1
    v_cndmask_b32 v60, 0, v48, vcc
    v_cmp_eq_u32 vcc, 0, v50
    s_nop 1
    v_cndmask_b32 v16, 0, v48, vcc
    v_cmp_eq_u32 vcc, 1, v49
    s_nop 1
    v_cndmask_b32 v61, 0, v48, vcc
    v_cmp_eq_u32 vcc, 2, v50
    s_nop 1
    v_cndmask_b32 v17, 0, v48, vcc
    v_cmp_eq_u32 vcc, 2, v49
    s_nop 1
    v_cndmask_b32 v62, 0, v48, vcc
    v_cmp_eq_u32 vcc, 4, v50
    s_nop 1
    v_cndmask_b32 v18, 0, v48, vcc
    v_cmp_eq_u32 vcc, 3, v49
    s_nop 1
    v_cndmask_b32 v63, 0, v48, vcc
    v_cmp_eq_u32 vcc, 6, v50
    s_nop 1
    v_cndmask_b32 v19, 0, v48, vcc
    v_and_b32 v48, 15, v9
    v_lshlrev_b32 v48, 6, v48
    v_and_b32 v49, 48, v9
    v_add_u32 v10, v48, v49
    s_waitcnt lgkmcnt(0)
    s_add_u32 s34, s34, 0x01010101
    s_waitcnt vmcnt(40)
    v_lshlrev_b32 v24, 16, v24
    v_mul_f32 v27, 0xbfb8aa3b, v24
    v_exp_f32 v27, v27
    s_nop 0
    v_add_f32 v27, 1.0, v27
    v_rcp_f32 v27, v27
    s_nop 0
    v_mul_f32 v24, v24, v27
    v_cvt_pk_bf16_f32 v24, v24, v24
    v_lshlrev_b32 v25, 16, v25
    v_mul_f32 v27, 0xbfb8aa3b, v25
    v_exp_f32 v27, v27
    s_nop 0
    v_add_f32 v27, 1.0, v27
    v_rcp_f32 v27, v27
    s_nop 0
    v_mul_f32 v25, v25, v27
    v_cvt_pk_bf16_f32 v25, v25, v25
    v_lshlrev_b32 v26, 16, v26
    v_mul_f32 v27, 0xbfb8aa3b, v26
    v_exp_f32 v27, v27
    s_nop 0
    v_add_f32 v27, 1.0, v27
    v_rcp_f32 v27, v27
    s_nop 0
    v_mul_f32 v26, v26, v27
    v_cvt_pk_bf16_f32 v26, v26, v26
    v_and_b32_dpp v32, v24, v16 row_newbcast:0 row_mask:0xf bank_mask:0xf
    v_and_b32_dpp v33, v24, v17 row_newbcast:0 row_mask:0xf bank_mask:0xf
    v_and_b32_dpp v34, v24, v18 row_newbcast:0 row_mask:0xf bank_mask:0xf
    v_and_b32_dpp v35, v24, v19 row_newbcast:0 row_mask:0xf bank_mask:0xf
    v_and_b32_dpp v36, v24, v16 row_newbcast:1 row_mask:0xf bank_mask:0xf
    v_and_b32_dpp v37, v24, v17 row_newbcast:1 row_mask:0xf bank_mask:0xf
    v_and_b32_dpp v38, v24, v18 row_newbcast:1 row_mask:0xf bank_mask:0xf
    v_and_b32_dpp v39, v24, v19 row_newbcast:1 row_mask:0xf bank_mask:0xf
    s_waitcnt vmcnt(39)
    v_mfma_f32_16x16x32_bf16 v[20:23], v[32:35], v[64:67], 0
    v_and_b32_dpp v40, v24, v16 row_newbcast:2 row_mask:0xf bank_mask:0xf
    v_and_b32_dpp v41, v24, v17 row_newbcast:2 row_mask:0xf bank_mask:0xf
    v_and_b32_dpp v42, v24, v18 row_newbcast:2 row_mask:0xf bank_mask:0xf
    v_and_b32_dpp v43, v24, v19 row_newbcast:2 row_mask:0xf bank_mask:0xf
    s_waitcnt vmcnt(38)
    v_mfma_f32_16x16x32_bf16 v[20:23], v[36:39], v[68:71], v[20:23]
    v_and_b32_dpp v44, v24, v16 row_newbcast:3 row_mask:0xf bank_mask:0xf
    v_and_b32_dpp v45, v24, v17 row_newbcast:3 row_mask:0xf bank_mask:0xf
    v_and_b32_dpp v46, v24, v18 row_newbcast:3 row_mask:0xf bank_mask:0xf
    v_and_b32_dpp v47, v24, v19 row_newbcast:3 row_mask:0xf bank_mask:0xf
    s_waitcnt vmcnt(37)
    v_mfma_f32_16x16x32_bf16 v[20:23], v[40:43], v[72:75], v[20:23]
    v_and_b32_dpp v32, v24, v16 row_newbcast:4 row_mask:0xf bank_mask:0xf
    v_and_b32_dpp v33, v24, v17 row_newbcast:4 row_mask:0xf bank_mask:0xf
    v_and_b32_dpp v34, v24, v18 row_newbcast:4 row_mask:0xf bank_mask:0xf
    v_and_b32_dpp v35, v24, v19 row_newbcast:4 row_mask:0xf bank_mask:0xf
    s_waitcnt vmcnt(36)
    v_mfma_f32_16x16x32_bf16 v[20:23], v[44:47], v[76:79], v[20:23]
    v_and_b32_dpp v36, v24, v16 row_newbcast:5 row_mask:0xf bank_mask:0xf
    v_and_b32_dpp v37, v24, v17 row_newbcast:5 row_mask:0xf bank_mask:0xf
    v_and_b32_dpp v38, v24, v18 row_newbcast:5 row_mask:0xf bank_mask:0xf
    v_and_b32_dpp v39, v24, v19 row_newbcast:5 row_mask:0xf bank_mask:0xf
    s_waitcnt vmcnt(35)
    v_mfma_f32_16x16x32_bf16 v[20:23], v[32:35], v[80:83], v[20:23]
    v_and_b32_dpp v40, v24, v16 row_newbcast:6 row_mask:0xf bank_mask:0xf
    v_and_b32_dpp v41, v24, v17 row_newbcast:6 row_mask:0xf bank_mask:0xf
    v_and_b32_dpp v42, v24, v18 row_newbcast:6 row_mask:0xf bank_mask:0xf
    v_and_b32_dpp v43, v24, v19 row_newbcast:6 row_mask:0xf bank_mask:0xf
    s_waitcnt vmcnt(34)
    v_mfma_f32_16x16x32_bf16 v[20:23], v[36:39], v[84:87], v[20:23]
    v_and_b32_dpp v44, v24, v16 row_newbcast:7 row_mask:0xf bank_mask:0xf
    v_and_b32_dpp v45, v24, v17 row_newbcast:7 row_mask:0xf bank_mask:0xf
    v_and_b32_dpp v46, v24, v18 row_newbcast:7 row_mask:0xf bank_mask:0xf
    v_and_b32_dpp v47, v24, v19 row_newbcast:7 row_mask:0xf bank_mask:0xf
    s_waitcnt vmcnt(33)
    v_mfma_f32_16x16x32_bf16 v[20:23], v[40:43], v[88:91], v[20:23]
    v_and_b32_dpp v32, v24, v16 row_newbcast:8 row_mask:0xf bank_mask:0xf
    v_and_b32_dpp v33, v24, v17 row_newbcast:8 row_mask:0xf bank_mask:0xf
    v_and_b32_dpp v34, v24, v18 row_newbcast:8 row_mask:0xf bank_mask:0xf
    v_and_b32_dpp v35, v24, v19 row_newbcast:8 row_mask:0xf bank_mask:0xf
    s_waitcnt vmcnt(32)
    v_mfma_f32_16x16x32_bf16 v[20:23], v[44:47], v[92:95], v[20:23]
    v_and_b32_dpp v36, v24, v16 row_newbcast:9 row_mask:0xf bank_mask:0xf
    v_and_b32_dpp v37, v24, v17 row_newbcast:9 row_mask:0xf bank_mask:0xf
    v_and_b32_dpp v38, v24, v18 row_newbcast:9 row_mask:0xf bank_mask:0xf
    v_and_b32_dpp v39, v24, v19 row_newbcast:9 row_mask:0xf bank_mask:0xf
    s_waitcnt vmcnt(31)
    v_mfma_f32_16x16x32_bf16 v[20:23], v[32:35], v[96:99], v[20:23]
    v_and_b32_dpp v40, v24, v16 row_newbcast:10 row_mask:0xf bank_mask:0xf
    v_and_b32_dpp v41, v24, v17 row_newbcast:10 row_mask:0xf bank_mask:0xf
    v_and_b32_dpp v42, v24, v18 row_newbcast:10 row_mask:0xf bank_mask:0xf
    v_and_b32_dpp v43, v24, v19 row_newbcast:10 row_mask:0xf bank_mask:0xf
    s_waitcnt vmcnt(30)
    v_mfma_f32_16x16x32_bf16 v[20:23], v[36:39], v[100:103], v[20:23]
    v_and_b32_dpp v44, v24, v16 row_newbcast:11 row_mask:0xf bank_mask:0xf
    v_and_b32_dpp v45, v24, v17 row_newbcast:11 row_mask:0xf bank_mask:0xf
    v_and_b32_dpp v46, v24, v18 row_newbcast:11 row_mask:0xf bank_mask:0xf
    v_and_b32_dpp v47, v24, v19 row_newbcast:11 row_mask:0xf bank_mask:0xf
    s_waitcnt vmcnt(29)
    v_mfma_f32_16x16x32_bf16 v[20:23], v[40:43], v[104:107], v[20:23]
    v_and_b32_dpp v32, v24, v16 row_newbcast:12 row_mask:0xf bank_mask:0xf
    v_and_b32_dpp v33, v24, v17 row_newbcast:12 row_mask:0xf bank_mask:0xf
    v_and_b32_dpp v34, v24, v18 row_newbcast:12 row_mask:0xf bank_mask:0xf
    v_and_b32_dpp v35, v24, v19 row_newbcast:12 row_mask:0xf bank_mask:0xf
    s_waitcnt vmcnt(28)
    v_mfma_f32_16x16x32_bf16 v[20:23], v[44:47], v[108:111], v[20:23]
    v_and_b32_dpp v36, v24, v16 row_newbcast:13 row_mask:0xf bank_mask:0xf
    v_and_b32_dpp v37, v24, v17 row_newbcast:13 row_mask:0xf bank_mask:0xf
    v_and_b32_dpp v38, v24, v18 row_newbcast:13 row_mask:0xf bank_mask:0xf
    v_and_b32_dpp v39, v24, v19 row_newbcast:13 row_mask:0xf bank_mask:0xf
    s_waitcnt vmcnt(27)
    v_mfma_f32_16x16x32_bf16 v[20:23], v[32:35], v[112:115], v[20:23]
    v_and_b32_dpp v40, v24, v16 row_newbcast:14 row_mask:0xf bank_mask:0xf
    v_and_b32_dpp v41, v24, v17 row_newbcast:14 row_mask:0xf bank_mask:0xf
    v_and_b32_dpp v42, v24, v18 row_newbcast:14 row_mask:0xf bank_mask:0xf
    v_and_b32_dpp v43, v24, v19 row_newbcast:14 row_mask:0xf bank_mask:0xf
    s_waitcnt vmcnt(26)
    v_mfma_f32_16x16x32_bf16 v[20:23], v[36:39], v[116:119], v[20:23]
    v_and_b32_dpp v44, v24, v16 row_newbcast:15 row_mask:0xf bank_mask:0xf
    v_and_b32_dpp v45, v24, v17 row_newbcast:15 row_mask:0xf bank_mask:0xf
    v_and_b32_dpp v46, v24, v18 row_newbcast:15 row_mask:0xf bank_mask:0xf
    v_and_b32_dpp v47, v24, v19 row_newbcast:15 row_mask:0xf bank_mask:0xf
    s_waitcnt vmcnt(25)
    v_mfma_f32_16x16x32_bf16 v[20:23], v[40:43], v[120:123], v[20:23]
    v_and_b32_dpp v32, v25, v16 row_newbcast:0 row_mask:0xf bank_mask:0xf
    v_and_b32_dpp v33, v25, v17 row_newbcast:0 row_mask:0xf bank_mask:0xf
    v_and_b32_dpp v34, v25, v18 row_newbcast:0 row_mask:0xf bank_mask:0xf
    v_and_b32_dpp v35, v25, v19 row_newbcast:0 row_mask:0xf bank_mask:0xf
    s_waitcnt vmcnt(24)
    v_mfma_f32_16x16x32_bf16 v[20:23], v[44:47], v[124:127], v[20:23]
    v_and_b32_dpp v36, v25, v16 row_newbcast:1 row_mask:0xf bank_mask:0xf
    v_and_b32_dpp v37, v25, v17 row_newbcast:1 row_mask:0xf bank_mask:0xf
    v_and_b32_dpp v38, v25, v18 row_newbcast:1 row_mask:0xf bank_mask:0xf
    v_and_b32_dpp v39, v25, v19 row_newbcast:1 row_mask:0xf bank_mask:0xf
    s_waitcnt vmcnt(23)
    v_mfma_f32_16x16x32_bf16 v[20:23], v[32:35], v[128:131], v[20:23]
    v_and_b32_dpp v40, v25, v16 row_newbcast:2 row_mask:0xf bank_mask:0xf
    v_and_b32_dpp v41, v25, v17 row_newbcast:2 row_mask:0xf bank_mask:0xf
    v_and_b32_dpp v42, v25, v18 row_newbcast:2 row_mask:0xf bank_mask:0xf
    v_and_b32_dpp v43, v25, v19 row_newbcast:2 row_mask:0xf bank_mask:0xf
    s_waitcnt vmcnt(22)
    v_mfma_f32_16x16x32_bf16 v[20:23], v[36:39], v[132:135], v[20:23]
    v_and_b32_dpp v44, v25, v16 row_newbcast:3 row_mask:0xf bank_mask:0xf
    v_and_b32_dpp v45, v25, v17 row_newbcast:3 row_mask:0xf bank_mask:0xf
    v_and_b32_dpp v46, v25, v18 row_newbcast:3 row_mask:0xf bank_mask:0xf
    v_and_b32_dpp v47, v25, v19 row_newbcast:3 row_mask:0xf bank_mask:0xf
    s_waitcnt vmcnt(21)
    v_mfma_f32_16x16x32_bf16 v[20:23], v[40:43], v[136:139], v[20:23]
    v_and_b32_dpp v32, v25, v16 row_newbcast:4 row_mask:0xf bank_mask:0xf
    v_and_b32_dpp v33, v25, v17 row_newbcast:4 row_mask:0xf bank_mask:0xf
    v_and_b32_dpp v34, v25, v18 row_newbcast:4 row_mask:0xf bank_mask:0xf
    v_and_b32_dpp v35, v25, v19 row_newbcast:4 row_mask:0xf bank_mask:0xf
    s_waitcnt vmcnt(20)
    v_mfma_f32_16x16x32_bf16 v[20:23], v[44:47], v[140:143], v[20:23]
    v_and_b32_dpp v36, v25, v16 row_newbcast:5 row_mask:0xf bank_mask:0xf
    v_and_b32_dpp v37, v25, v17 row_newbcast:5 row_mask:0xf bank_mask:0xf
    v_and_b32_dpp v38, v25, v18 row_newbcast:5 row_mask:0xf bank_mask:0xf
    v_and_b32_dpp v39, v25, v19 row_newbcast:5 row_mask:0xf bank_mask:0xf
    s_waitcnt vmcnt(19)
    v_mfma_f32_16x16x32_bf16 v[20:23], v[32:35], v[144:147], v[20:23]
    v_and_b32_dpp v40, v25, v16 row_newbcast:6 row_mask:0xf bank_mask:0xf
    v_and_b32_dpp v41, v25, v17 row_newbcast:6 row_mask:0xf bank_mask:0xf
    v_and_b32_dpp v42, v25, v18 row_newbcast:6 row_mask:0xf bank_mask:0xf
    v_and_b32_dpp v43, v25, v19 row_newbcast:6 row_mask:0xf bank_mask:0xf
    s_waitcnt vmcnt(18)
    v_mfma_f32_16x16x32_bf16 v[20:23], v[36:39], v[148:151], v[20:23]
    v_and_b32_dpp v44, v25, v16 row_newbcast:7 row_mask:0xf bank_mask:0xf
    v_and_b32_dpp v45, v25, v17 row_newbcast:7 row_mask:0xf bank_mask:0xf
    v_and_b32_dpp v46, v25, v18 row_newbcast:7 row_mask:0xf bank_mask:0xf
    v_and_b32_dpp v47, v25, v19 row_newbcast:7 row_mask:0xf bank_mask:0xf
    s_waitcnt vmcnt(17)
    v_mfma_f32_16x16x32_bf16 v[20:23], v[40:43], v[152:155], v[20:23]
    v_and_b32_dpp v32, v25, v16 row_newbcast:8 row_mask:0xf bank_mask:0xf
    v_and_b32_dpp v33, v25, v17 row_newbcast:8 row_mask:0xf bank_mask:0xf
    v_and_b32_dpp v34, v25, v18 row_newbcast:8 row_mask:0xf bank_mask:0xf
    v_and_b32_dpp v35, v25, v19 row_newbcast:8 row_mask:0xf bank_mask:0xf
    s_waitcnt vmcnt(16)
    v_mfma_f32_16x16x32_bf16 v[20:23], v[44:47], v[156:159], v[20:23]
    v_and_b32_dpp v36, v25, v16 row_newbcast:9 row_mask:0xf bank_mask:0xf
    v_and_b32_dpp v37, v25, v17 row_newbcast:9 row_mask:0xf bank_mask:0xf
    v_and_b32_dpp v38, v25, v18 row_newbcast:9 row_mask:0xf bank_mask:0xf
    v_and_b32_dpp v39, v25, v19 row_newbcast:9 row_mask:0xf bank_mask:0xf
    s_waitcnt vmcnt(15)
    v_mfma_f32_16x16x32_bf16 v[20:23], v[32:35], v[160:163], v[20:23]
    v_and_b32_dpp v40, v25, v16 row_newbcast:10 row_mask:0xf bank_mask:0xf
    v_and_b32_dpp v41, v25, v17 row_newbcast:10 row_mask:0xf bank_mask:0xf
    v_and_b32_dpp v42, v25, v18 row_newbcast:10 row_mask:0xf bank_mask:0xf
    v_and_b32_dpp v43, v25, v19 row_newbcast:10 row_mask:0xf bank_mask:0xf
    s_waitcnt vmcnt(14)
    v_mfma_f32_16x16x32_bf16 v[20:23], v[36:39], v[164:167], v[20:23]
    v_and_b32_dpp v44, v25, v16 row_newbcast:11 row_mask:0xf bank_mask:0xf
    v_and_b32_dpp v45, v25, v17 row_newbcast:11 row_mask:0xf bank_mask:0xf
    v_and_b32_dpp v46, v25, v18 row_newbcast:11 row_mask:0xf bank_mask:0xf
    v_and_b32_dpp v47, v25, v19 row_newbcast:11 row_mask:0xf bank_mask:0xf
    s_waitcnt vmcnt(13)
    v_mfma_f32_16x16x32_bf16 v[20:23], v[40:43], v[168:171], v[20:23]
    v_and_b32_dpp v32, v25, v16 row_newbcast:12 row_mask:0xf bank_mask:0xf
    v_and_b32_dpp v33, v25, v17 row_newbcast:12 row_mask:0xf bank_mask:0xf
    v_and_b32_dpp v34, v25, v18 row_newbcast:12 row_mask:0xf bank_mask:0xf
    v_and_b32_dpp v35, v25, v19 row_newbcast:12 row_mask:0xf bank_mask:0xf
    s_waitcnt vmcnt(12)
    v_mfma_f32_16x16x32_bf16 v[20:23], v[44:47], v[172:175], v[20:23]
    v_and_b32_dpp v36, v25, v16 row_newbcast:13 row_mask:0xf bank_mask:0xf
    v_and_b32_dpp v37, v25, v17 row_newbcast:13 row_mask:0xf bank_mask:0xf
    v_and_b32_dpp v38, v25, v18 row_newbcast:13 row_mask:0xf bank_mask:0xf
    v_and_b32_dpp v39, v25, v19 row_newbcast:13 row_mask:0xf bank_mask:0xf
    s_waitcnt vmcnt(11)
    v_mfma_f32_16x16x32_bf16 v[20:23], v[32:35], v[176:179], v[20:23]
    v_and_b32_dpp v40, v25, v16 row_newbcast:14 row_mask:0xf bank_mask:0xf
    v_and_b32_dpp v41, v25, v17 row_newbcast:14 row_mask:0xf bank_mask:0xf
    v_and_b32_dpp v42, v25, v18 row_newbcast:14 row_mask:0xf bank_mask:0xf
    v_and_b32_dpp v43, v25, v19 row_newbcast:14 row_mask:0xf bank_mask:0xf
    s_waitcnt vmcnt(10)
    v_mfma_f32_16x16x32_bf16 v[20:23], v[36:39], v[180:183], v[20:23]
    v_and_b32_dpp v44, v25, v16 row_newbcast:15 row_mask:0xf bank_mask:0xf
    v_and_b32_dpp v45, v25, v17 row_newbcast:15 row_mask:0xf bank_mask:0xf
    v_and_b32_dpp v46, v25, v18 row_newbcast:15 row_mask:0xf bank_mask:0xf
    v_and_b32_dpp v47, v25, v19 row_newbcast:15 row_mask:0xf bank_mask:0xf
    s_waitcnt vmcnt(9)
    v_mfma_f32_16x16x32_bf16 v[20:23], v[40:43], v[184:187], v[20:23]
    v_and_b32_dpp v32, v26, v16 row_newbcast:0 row_mask:0xf bank_mask:0xf
    v_and_b32_dpp v33, v26, v17 row_newbcast:0 row_mask:0xf bank_mask:0xf
    v_and_b32_dpp v34, v26, v18 row_newbcast:0 row_mask:0xf bank_mask:0xf
    v_and_b32_dpp v35, v26, v19 row_newbcast:0 row_mask:0xf bank_mask:0xf
    s_waitcnt vmcnt(8)
    v_mfma_f32_16x16x32_bf16 v[20:23], v[44:47], v[188:191], v[20:23]
    v_and_b32_dpp v36, v26, v16 row_newbcast:1 row_mask:0xf bank_mask:0xf
    v_and_b32_dpp v37, v26, v17 row_newbcast:1 row_mask:0xf bank_mask:0xf
    v_and_b32_dpp v38, v26, v18 row_newbcast:1 row_mask:0xf bank_mask:0xf
    v_and_b32_dpp v39, v26, v19 row_newbcast:1 row_mask:0xf bank_mask:0xf
    s_waitcnt vmcnt(7)
    v_mfma_f32_16x16x32_bf16 v[20:23], v[32:35], v[192:195], v[20:23]
    v_and_b32_dpp v40, v26, v16 row_newbcast:2 row_mask:0xf bank_mask:0xf
    v_and_b32_dpp v41, v26, v17 row_newbcast:2 row_mask:0xf bank_mask:0xf
    v_and_b32_dpp v42, v26, v18 row_newbcast:2 row_mask:0xf bank_mask:0xf
    v_and_b32_dpp v43, v26, v19 row_newbcast:2 row_mask:0xf bank_mask:0xf
    s_waitcnt vmcnt(6)
    v_mfma_f32_16x16x32_bf16 v[20:23], v[36:39], v[196:199], v[20:23]
    v_and_b32_dpp v44, v26, v16 row_newbcast:3 row_mask:0xf bank_mask:0xf
    v_and_b32_dpp v45, v26, v17 row_newbcast:3 row_mask:0xf bank_mask:0xf
    v_and_b32_dpp v46, v26, v18 row_newbcast:3 row_mask:0xf bank_mask:0xf
    v_and_b32_dpp v47, v26, v19 row_newbcast:3 row_mask:0xf bank_mask:0xf
    s_waitcnt vmcnt(5)
    v_mfma_f32_16x16x32_bf16 v[20:23], v[40:43], v[200:203], v[20:23]
    v_and_b32_dpp v32, v26, v16 row_newbcast:4 row_mask:0xf bank_mask:0xf
    v_and_b32_dpp v33, v26, v17 row_newbcast:4 row_mask:0xf bank_mask:0xf
    v_and_b32_dpp v34, v26, v18 row_newbcast:4 row_mask:0xf bank_mask:0xf
    v_and_b32_dpp v35, v26, v19 row_newbcast:4 row_mask:0xf bank_mask:0xf
    s_waitcnt vmcnt(4)
    v_mfma_f32_16x16x32_bf16 v[20:23], v[44:47], v[204:207], v[20:23]
    v_and_b32_dpp v36, v26, v16 row_newbcast:5 row_mask:0xf bank_mask:0xf
    v_and_b32_dpp v37, v26, v17 row_newbcast:5 row_mask:0xf bank_mask:0xf
    v_and_b32_dpp v38, v26, v18 row_newbcast:5 row_mask:0xf bank_mask:0xf
    v_and_b32_dpp v39, v26, v19 row_newbcast:5 row_mask:0xf bank_mask:0xf
    s_waitcnt vmcnt(3)
    v_mfma_f32_16x16x32_bf16 v[20:23], v[32:35], v[208:211], v[20:23]
    v_and_b32_dpp v40, v26, v16 row_newbcast:6 row_mask:0xf bank_mask:0xf
    v_and_b32_dpp v41, v26, v17 row_newbcast:6 row_mask:0xf bank_mask:0xf
    v_and_b32_dpp v42, v26, v18 row_newbcast:6 row_mask:0xf bank_mask:0xf
    v_and_b32_dpp v43, v26, v19 row_newbcast:6 row_mask:0xf bank_mask:0xf
    s_waitcnt vmcnt(2)
    v_mfma_f32_16x16x32_bf16 v[20:23], v[36:39], v[212:215], v[20:23]
    v_and_b32_dpp v44, v26, v16 row_newbcast:7 row_mask:0xf bank_mask:0xf
    v_and_b32_dpp v45, v26, v17 row_newbcast:7 row_mask:0xf bank_mask:0xf
    v_and_b32_dpp v46, v26, v18 row_newbcast:7 row_mask:0xf bank_mask:0xf
    v_and_b32_dpp v47, v26, v19 row_newbcast:7 row_mask:0xf bank_mask:0xf
    s_waitcnt vmcnt(1)
    v_mfma_f32_16x16x32_bf16 v[20:23], v[40:43], v[216:219], v[20:23]
    s_waitcnt vmcnt(0)
    v_mfma_f32_16x16x32_bf16 v[20:23], v[44:47], v[220:223], v[20:23]
    s_nop 7
    v_mov_b32 v23, s34
    buffer_store_dwordx4 v[20:23], v1, s[48:51], s6 offen sc1
    s_branch L_hop2
L_ctrl_none:
    s_cmp_lt_u32 s35, 10
    s_cbranch_scc1 L_lwo_25
    s_cmp_ge_u32 s65, 54
    s_cbranch_scc1 L_ldone_26
    s_cmp_gt_u32 s3, 3
    s_cbranch_scc1 L_ldone_26
    v_and_b32 v34, 4, v9
    v_cmp_eq_u32 vcc, 0, v34
    v_mov_b32 v34, s18
    v_mov_b32 v35, s16
    v_cndmask_b32 v38, v34, v35, vcc
    v_mov_b32 v34, s19
    v_mov_b32 v35, s17
    v_cndmask_b32 v39, v34, v35, vcc
    s_mul_i32 s69, s3, 552960
    s_lshl_b32 s68, s65, 6
    s_add_u32 s69, s69, s68
    v_and_b32 v36, 3, v9
    v_lshl_add_u32 v36, v36, 4, s69
    v_lshrrev_b32 v37, 3, v9
    v_mul_u32_u24 v33, 55296, v37
    v_add_u32 v33, v33, v36
    v_add_co_u32 v34, vcc, v38, v33
    s_nop 1
    v_addc_co_u32 v35, vcc, 0, v39, vcc
    global_load_dwordx4 v[112:115], v[34:35], off offset:0
    global_load_dwordx4 v[128:131], v[34:35], off offset:3456
    v_add_co_u32 v34, vcc, 6912, v34
    s_nop 1
    v_addc_co_u32 v35, vcc, 0, v35, vcc
    global_load_dwordx4 v[144:147], v[34:35], off offset:0
    global_load_dwordx4 v[160:163], v[34:35], off offset:3456
    v_add_co_u32 v34, vcc, 6912, v34
    s_nop 1
    v_addc_co_u32 v35, vcc, 0, v35, vcc
    global_load_dwordx4 v[116:119], v[34:35], off offset:0
    global_load_dwordx4 v[132:135], v[34:35], off offset:3456
    v_add_co_u32 v34, vcc, 6912, v34
    s_nop 1
    v_addc_co_u32 v35, vcc, 0, v35, vcc
    global_load_dwordx4 v[148:151], v[34:35], off offset:0
    global_load_dwordx4 v[164:167], v[34:35], off offset:3456
    v_add_co_u32 v34, vcc, 6912, v34
    s_nop 1
    v_addc_co_u32 v35, vcc, 0, v35, vcc
    global_load_dwordx4 v[120:123], v[34:35], off offset:0
    global_load_dwordx4 v[136:139], v[34:35], off offset:3456
    v_add_co_u32 v34, vcc, 6912, v34
    s_nop 1
    v_addc_co_u32 v35, vcc, 0, v35, vcc
    global_load_dwordx4 v[152:155], v[34:35], off offset:0
    global_load_dwordx4 v[168:171], v[34:35], off offset:3456
    v_add_co_u32 v34, vcc, 6912, v34
    s_nop 1
    v_addc_co_u32 v35, vcc, 0, v35, vcc
    global_load_dwordx4 v[124:127], v[34:35], off offset:0
    global_load_dwordx4 v[140:143], v[34:35], off offset:3456
    v_add_co_u32 v34, vcc, 6912, v34
    s_nop 1
    v_addc_co_u32 v35, vcc, 0, v35, vcc
    global_load_dwordx4 v[156:159], v[34:35], off offset:0
    global_load_dwordx4 v[172:175], v[34:35], off offset:3456
    v_mul_u32_u24 v33, 13824, v37
    v_add_u32 v33, v33, v36
    v_add_u32 v33, 442368, v33
    v_add_co_u32 v34, vcc, v38, v33
    s_nop 1
    v_addc_co_u32 v35, vcc, 0, v39, vcc
    global_load_dwordx4 v[176:179], v[34:35], off offset:0
    global_load_dwordx4 v[180:183], v[34:35], off offset:3456
    v_add_co_u32 v34, vcc, 6912, v34
    s_nop 1
    v_addc_co_u32 v35, vcc, 0, v35, vcc
    global_load_dwordx4 v[184:187], v[34:35], off offset:0
    global_load_dwordx4 v[188:191], v[34:35], off offset:3456
    s_branch L_ldone_26
L_lwo_25:
    s_mov_b32 s52, s12
    s_mov_b32 s53, s13
    s_mov_b32 s54, 5242880
    s_mov_b32 s55, 0x20000
    v_bfe_u32 v49, v9, 4, 1
    v_lshlrev_b32 v49, 5, v49
    v_lshrrev_b32 v50, 5, v9
    v_add_u32 v49, v49, v50
    v_bfe_u32 v50, v9, 3, 1
    v_lshl_add_u32 v49, v50, 4, v49
    v_mul_u32_u24 v49, 1280, v49
    v_and_b32 v50, 7, v9
    v_lshl_add_u32 v49, v50, 4, v49
    s_lshr_b32 s68, s3, 1
    s_lshl_b32 s68, s68, 3
    s_add_u32 s68, s68, s36
    s_lshl_b32 s68, s68, 1
    s_and_b32 s69, s3, 1
    s_add_u32 s68, s68, s69
    s_mul_i32 s69, s68, 81920
    s_lshl_b32 s68, s35, 7
    s_add_u32 s69, s69, s68
    s_add_u32 s68, s69, 0
    buffer_load_dwordx4 v[112:115], v49, s[52:55], s68 offen offset:0
    buffer_load_dwordx4 v[116:119], v49, s[52:55], s68 offen offset:2560
    s_add_u32 s68, s69, 5120
    buffer_load_dwordx4 v[120:123], v49, s[52:55], s68 offen offset:0
    buffer_load_dwordx4 v[124:127], v49, s[52:55], s68 offen offset:2560
    s_add_u32 s68, s69, 10240
    buffer_load_dwordx4 v[128:131], v49, s[52:55], s68 offen offset:0
    buffer_load_dwordx4 v[132:135], v49, s[52:55], s68 offen offset:2560
    s_add_u32 s68, s69, 15360
    buffer_load_dwordx4 v[136:139], v49, s[52:55], s68 offen offset:0
    buffer_load_dwordx4 v[140:143], v49, s[52:55], s68 offen offset:2560
L_ldone_26:
    s_load_dword s34, s[30:31], 0
    s_mov_b32 s48, s30
    s_mov_b32 s49, s31
    s_mov_b32 s50, 3933184
    s_mov_b32 s51, 0x20000
    v_and_b32 v48, 1, v9
    v_lshlrev_b32 v48, 4, v48
    v_mov_b32 v49, 0xffff
    v_lshlrev_b32 v48, v48, v49
    v_bfe_u32 v49, v9, 1, 2
    v_bfe_u32 v50, v9, 1, 3
    v_cmp_eq_u32 vcc, 0, v49
    s_nop 1
    v_cndmask_b32 v60, 0, v48, vcc
    v_cmp_eq_u32 vcc, 0, v50
    s_nop 1
    v_cndmask_b32 v16, 0, v48, vcc
    v_cmp_eq_u32 vcc, 1, v49
    s_nop 1
    v_cndmask_b32 v61, 0, v48, vcc
    v_cmp_eq_u32 vcc, 2, v50
    s_nop 1
    v_cndmask_b32 v17, 0, v48, vcc
    v_cmp_eq_u32 vcc, 2, v49
    s_nop 1
    v_cndmask_b32 v62, 0, v48, vcc
    v_cmp_eq_u32 vcc, 4, v50
    s_nop 1
    v_cndmask_b32 v18, 0, v48, vcc
    v_cmp_eq_u32 vcc, 3, v49
    s_nop 1
    v_cndmask_b32 v63, 0, v48, vcc
    v_cmp_eq_u32 vcc, 6, v50
    s_nop 1
    v_cndmask_b32 v19, 0, v48, vcc
    v_and_b32 v48, 15, v9
    v_lshlrev_b32 v48, 6, v48
    v_and_b32 v49, 48, v9
    v_add_u32 v10, v48, v49
    s_waitcnt lgkmcnt(0)
    s_add_u32 s34, s34, 0x01010101
    s_branch L_hop2
L_ctrl_q:
    s_and_b32 s38, s35, 3
    s_lshl_b32 s38, s38, 3
    s_add_u32 s38, s38, s36
    s_bfe_u32 s37, s35, 0x10002
    s_mul_i32 s68, s37, 3
    s_add_u32 s39, s39, s68
    s_mov_b32 s56, s4
    s_mov_b32 s57, s5
    s_mov_b32 s58, 1280
    s_mov_b32 s59, 0x20000
    s_mov_b32 s52, s10
    s_mov_b32 s53, s11
    s_mov_b32 s54, 5242880
    s_mov_b32 s55, 0x20000
    v_lshlrev_b32 v50, 2, v9
    buffer_load_dword v65, v50, s[56:59], 0 offen offset:0
    buffer_load_dword v67, v50, s[56:59], 0 offen offset:256
    buffer_load_dword v69, v50, s[56:59], 0 offen offset:512
    buffer_load_dword v71, v50, s[56:59], 0 offen offset:768
    buffer_load_dword v73, v50, s[56:59], 0 offen offset:1024
    s_lshl_b32 s68, s39, 8
    v_lshrrev_b32 v48, 4, v9
    v_and_b32 v49, 15, v9
    v_lshlrev_b32 v50, 2, v48
    v_lshl_add_u32 v50, v49, 4, v50
    buffer_load_dword v25, v50, s[56:59], s68 offen
    v_lshlrev_b32 v48, 14, v48
    v_lshl_add_u32 v51, v49, 4, v48
    s_lshl_b32 s69, s39, 20
    s_lshl_b32 s68, s38, 8
    s_add_u32 s69, s69, s68
    s_add_u32 s68, s69, 0
    buffer_load_dwordx4 v[128:131], v51, s[52:55], s68 offen nt
    s_add_u32 s68, s69, 65536
    buffer_load_dwordx4 v[132:135], v51, s[52:55], s68 offen nt
    s_add_u32 s68, s69, 131072
    buffer_load_dwordx4 v[136:139], v51, s[52:55], s68 offen nt
    s_add_u32 s68, s69, 196608
    buffer_load_dwordx4 v[140:143], v51, s[52:55], s68 offen nt
    s_add_u32 s68, s69, 262144
    buffer_load_dwordx4 v[144:147], v51, s[52:55], s68 offen nt
    s_add_u32 s68, s69, 327680
    buffer_load_dwordx4 v[148:151], v51, s[52:55], s68 offen nt
    s_add_u32 s68, s69, 393216
    buffer_load_dwordx4 v[152:155], v51, s[52:55], s68 offen nt
    s_add_u32 s68, s69, 458752
    buffer_load_dwordx4 v[156:159], v51, s[52:55], s68 offen nt
    s_add_u32 s68, s69, 524288
    buffer_load_dwordx4 v[160:163], v51, s[52:55], s68 offen nt
    s_add_u32 s68, s69, 589824
    buffer_load_dwordx4 v[164:167], v51, s[52:55], s68 offen nt
    s_add_u32 s68, s69, 655360
    buffer_load_dwordx4 v[168:171], v51, s[52:55], s68 offen nt
    s_add_u32 s68, s69, 720896
    buffer_load_dwordx4 v[172:175], v51, s[52:55], s68 offen nt
    s_add_u32 s68, s69, 786432
    buffer_load_dwordx4 v[176:179], v51, s[52:55], s68 offen nt
    s_add_u32 s68, s69, 851968
    buffer_load_dwordx4 v[180:183], v51, s[52:55], s68 offen nt
    s_add_u32 s68, s69, 917504
    buffer_load_dwordx4 v[184:187], v51, s[52:55], s68 offen nt
    s_add_u32 s68, s69, 983040
    buffer_load_dwordx4 v[188:191], v51, s[52:55], s68 offen nt
    s_add_u32 s68, s69, 8192
    buffer_load_dwordx4 v[192:195], v51, s[52:55], s68 offen nt
    s_add_u32 s68, s69, 73728
    buffer_load_dwordx4 v[196:199], v51, s[52:55], s68 offen nt
    s_add_u32 s68, s69, 139264
    buffer_load_dwordx4 v[200:203], v51, s[52:55], s68 offen nt
    s_add_u32 s68, s69, 204800
    buffer_load_dwordx4 v[204:207], v51, s[52:55], s68 offen nt
    s_add_u32 s68, s69, 270336
    buffer_load_dwordx4 v[208:211], v51, s[52:55], s68 offen nt
    s_add_u32 s68, s69, 335872
    buffer_load_dwordx4 v[212:215], v51, s[52:55], s68 offen nt
    s_add_u32 s68, s69, 401408
    buffer_load_dwordx4 v[216:219], v51, s[52:55], s68 offen nt
    s_add_u32 s68, s69, 466944
    buffer_load_dwordx4 v[220:223], v51, s[52:55], s68 offen nt
    s_add_u32 s68, s69, 532480
    buffer_load_dwordx4 v[224:227], v51, s[52:55], s68 offen nt
    s_add_u32 s68, s69, 598016
    buffer_load_dwordx4 v[228:231], v51, s[52:55], s68 offen nt
    s_add_u32 s68, s69, 663552
    buffer_load_dwordx4 v[232:235], v51, s[52:55], s68 offen nt
    s_add_u32 s68, s69, 729088
    buffer_load_dwordx4 v[236:239], v51, s[52:55], s68 offen nt
    s_add_u32 s68, s69, 794624
    buffer_load_dwordx4 v[240:243], v51, s[52:55], s68 offen nt
    s_add_u32 s68, s69, 860160
    buffer_load_dwordx4 v[244:247], v51, s[52:55], s68 offen nt
    s_add_u32 s68, s69, 925696
    buffer_load_dwordx4 v[248:251], v51, s[52:55], s68 offen nt
    s_add_u32 s68, s69, 991232
    buffer_load_dwordx4 v[252:255], v51, s[52:55], s68 offen nt
    s_load_dword s34, s[30:31], 0
    s_mov_b32 s48, s30
    s_mov_b32 s49, s31
    s_mov_b32 s50, 3933184
    s_mov_b32 s51, 0x20000
    v_and_b32 v48, 1, v9
    v_lshlrev_b32 v48, 4, v48
    v_mov_b32 v49, 0xffff
    v_lshlrev_b32 v48, v48, v49
    v_bfe_u32 v49, v9, 1, 2
    v_bfe_u32 v50, v9, 1, 3
    v_cmp_eq_u32 vcc, 0, v49
    s_nop 1
    v_cndmask_b32 v60, 0, v48, vcc
    v_cmp_eq_u32 vcc, 0, v50
    s_nop 1
    v_cndmask_b32 v16, 0, v48, vcc
    v_cmp_eq_u32 vcc, 1, v49
    s_nop 1
    v_cndmask_b32 v61, 0, v48, vcc
    v_cmp_eq_u32 vcc, 2, v50
    s_nop 1
    v_cndmask_b32 v17, 0, v48, vcc
    v_cmp_eq_u32 vcc, 2, v49
    s_nop 1
    v_cndmask_b32 v62, 0, v48, vcc
    v_cmp_eq_u32 vcc, 4, v50
    s_nop 1
    v_cndmask_b32 v18, 0, v48, vcc
    v_cmp_eq_u32 vcc, 3, v49
    s_nop 1
    v_cndmask_b32 v63, 0, v48, vcc
    v_cmp_eq_u32 vcc, 6, v50
    s_nop 1
    v_cndmask_b32 v19, 0, v48, vcc
    v_and_b32 v48, 15, v9
    v_lshlrev_b32 v48, 6, v48
    v_and_b32 v49, 48, v9
    v_add_u32 v10, v48, v49
    s_waitcnt lgkmcnt(0)
    s_add_u32 s34, s34, 0x01010101
    s_lshl_b32 s68, s38, 8
    s_add_u32 s68, s68, 413696
    s_cmp_lg_u32 s39, 0
    s_cbranch_scc1 L_nocnt
    s_mov_b64 exec, 1
    buffer_store_dword v2, v2, s[48:51], s68 offen sc1
    s_mov_b64 exec, -1
    s_waitcnt vmcnt(33)
    s_branch L_cntj
L_nocnt:
    s_waitcnt vmcnt(32)
L_cntj:
    v_lshlrev_b32 v64, 16, v65
    v_and_b32 v65, 0xffff0000, v65
    v_lshlrev_b32 v66, 16, v67
    v_and_b32 v67, 0xffff0000, v67
    v_lshlrev_b32 v68, 16, v69
    v_and_b32 v69, 0xffff0000, v69
    v_lshlrev_b32 v70, 16, v71
    v_and_b32 v71, 0xffff0000, v71
    v_lshlrev_b32 v72, 16, v73
    v_and_b32 v73, 0xffff0000, v73
    v_lshlrev_b32 v24, 16, v25
    v_and_b32 v25, 0xffff0000, v25
    v_add_f32 v56, v64, v65
    v_add_f32 v56, v56, v66
    v_add_f32 v56, v56, v67
    v_add_f32 v56, v56, v68
    v_add_f32 v56, v56, v69
    v_add_f32 v56, v56, v70
    v_add_f32 v56, v56, v71
    v_add_f32 v56, v56, v72
    v_add_f32 v56, v56, v73
    s_nop 1
    v_add_f32_dpp v56, v56, v56 quad_perm:[1,0,3,2] row_mask:0xf bank_mask:0xf
    s_nop 1
    v_add_f32_dpp v56, v56, v56 quad_perm:[2,3,0,1] row_mask:0xf bank_mask:0xf
    s_nop 1
    v_add_f32_dpp v56, v56, v56 row_ror:4 row_mask:0xf bank_mask:0xf
    s_nop 1
    v_add_f32_dpp v56, v56, v56 row_ror:8 row_mask:0xf bank_mask:0xf
    v_mov_b32 v57, v56
    s_nop 1
    v_permlane16_swap_b32 v56, v57
    v_add_f32 v56, v56, v57
    v_mov_b32 v57, v56
    s_nop 1
    v_permlane32_swap_b32 v56, v57
    v_add_f32 v56, v56, v57
    v_mul_f32 v56, 0x3acccccd, v56
    v_sub_f32 v64, v64, v56
    v_sub_f32 v65, v65, v56
    v_sub_f32 v66, v66, v56
    v_sub_f32 v67, v67, v56
    v_sub_f32 v68, v68, v56
    v_sub_f32 v69, v69, v56
    v_sub_f32 v70, v70, v56
    v_sub_f32 v71, v71, v56
    v_sub_f32 v72, v72, v56
    v_sub_f32 v73, v73, v56
    v_mul_f32 v58, v64, v64
    v_fmac_f32 v58, v65, v65
    v_fmac_f32 v58, v66, v66
    v_fmac_f32 v58, v67, v67
    v_fmac_f32 v58, v68, v68
    v_fmac_f32 v58, v69, v69
    v_fmac_f32 v58, v70, v70
    v_fmac_f32 v58, v71, v71
    v_fmac_f32 v58, v72, v72
    v_fmac_f32 v58, v73, v73
    s_nop 1
    v_add_f32_dpp v58, v58, v58 quad_perm:[1,0,3,2] row_mask:0xf bank_mask:0xf
    s_nop 1
    v_add_f32_dpp v58, v58, v58 quad_perm:[2,3,0,1] row_mask:0xf bank_mask:0xf
    s_nop 1
    v_add_f32_dpp v58, v58, v58 row_ror:4 row_mask:0xf bank_mask:0xf
    s_nop 1
    v_add_f32_dpp v58, v58, v58 row_ror:8 row_mask:0xf bank_mask:0xf
    v_mov_b32 v57, v58
    s_nop 1
    v_permlane16_swap_b32 v58, v57
    v_add_f32 v58, v58, v57
    v_mov_b32 v57, v58
    s_nop 1
    v_permlane32_swap_b32 v58, v57
    v_add_f32 v58, v58, v57
    v_mul_f32 v58, 0x3acccccd, v58
    v_cvt_pk_bf16_f32 v58, v56, v58
    v_lshlrev_b32 v56, 16, v58
    v_and_b32 v58, 0xffff0000, v58
    v_add_f32 v58, 0x3727c5ac, v58
    v_cvt_pk_bf16_f32 v58, v58, v58
    v_and_b32 v58, 0xffff0000, v58
    v_sqrt_f32 v58, v58
    s_nop 0
    v_cvt_pk_bf16_f32 v58, v58, v58
    v_and_b32 v58, 0xffff0000, v58
    v_rcp_f32 v58, v58
    v_sub_f32 v24, v24, v56
    v_sub_f32 v25, v25, v56
    v_cvt_pk_bf16_f32 v25, v24, v25
    v_lshlrev_b32 v24, 16, v25
    v_and_b32 v25, 0xffff0000, v25
    v_mul_f32 v24, v24, v58
    v_mul_f32 v25, v25, v58
    v_cvt_pk_bf16_f32 v25, v24, v25
    v_lshlrev_b32 v24, 16, v25
    v_and_b32 v25, 0xffff0000, v25
    s_lshl_b32 s6, s39, 12
    s_add_u32 s6, s6, 4096
    s_add_u32 s7, s6, 20480
    s_add_u32 s68, s30, s6
    s_addc_u32 s69, s31, 0
    s_mov_b32 s64, 0x40000
L_spoll_27:
    s_load_dword s40, s[68:69], 1020 glc
    s_load_dword s41, s[68:69], 2044 glc
    s_load_dword s42, s[68:69], 3068 glc
    s_load_dword s43, s[68:69], 4092 glc
    s_load_dword s44, s[68:69], 21500 glc
    s_load_dword s45, s[68:69], 22524 glc
    s_load_dword s46, s[68:69], 23548 glc
    s_load_dword s47, s[68:69], 24572 glc
    s_sub_u32 s64, s64, 1
    s_cmp_eq_u32 s64, 0
    s_cbranch_scc1 L_spd_28
    s_waitcnt lgkmcnt(0)
    s_cmp_lg_u32 s40, s34
    s_cbranch_scc1 L_spoll_27
    s_cmp_lg_u32 s41, s34
    s_cbranch_scc1 L_spoll_27
    s_cmp_lg_u32 s42, s34
    s_cbranch_scc1 L_spoll_27
    s_cmp_lg_u32 s43, s34
    s_cbranch_scc1 L_spoll_27
    s_cmp_lg_u32 s44, s34
    s_cbranch_scc1 L_spoll_27
    s_cmp_lg_u32 s45, s34
    s_cbranch_scc1 L_spoll_27
    s_cmp_lg_u32 s46, s34
    s_cbranch_scc1 L_spoll_27
    s_cmp_lg_u32 s47, s34
    s_cbranch_scc1 L_spoll_27
L_spd_28:
    s_waitcnt lgkmcnt(0)
    s_mov_b32 s64, 0x40000
L_poll_29:
    buffer_load_dwordx4 v[64:67], v1, s[48:51], s6 offen offset:0 sc1
    buffer_load_dwordx4 v[68:71], v1, s[48:51], s6 offen offset:1024 sc1
    buffer_load_dwordx4 v[72:75], v1, s[48:51], s6 offen offset:2048 sc1
    buffer_load_dwordx4 v[76:79], v1, s[48:51], s6 offen offset:3072 sc1
    buffer_load_dwordx4 v[80:83], v1, s[48:51], s7 offen offset:0 sc1
    buffer_load_dwordx4 v[84:87], v1, s[48:51], s7 offen offset:1024 sc1
    buffer_load_dwordx4 v[88:91], v1, s[48:51], s7 offen offset:2048 sc1
    buffer_load_dwordx4 v[92:95], v1, s[48:51], s7 offen offset:3072 sc1
    s_waitcnt vmcnt(7)
    v_xor_b32 v11, s34, v67
    s_waitcnt vmcnt(6)
    v_bitop3_b32 v11, v11, v71, s34 bitop3:0xf6
    s_waitcnt vmcnt(5)
    v_bitop3_b32 v11, v11, v75, s34 bitop3:0xf6
    s_waitcnt vmcnt(4)
    v_bitop3_b32 v11, v11, v79, s34 bitop3:0xf6
    s_waitcnt vmcnt(3)
    v_bitop3_b32 v11, v11, v83, s34 bitop3:0xf6
    s_waitcnt vmcnt(2)
    v_bitop3_b32 v11, v11, v87, s34 bitop3:0xf6
    s_waitcnt vmcnt(1)
    v_bitop3_b32 v11, v11, v91, s34 bitop3:0xf6
    s_waitcnt vmcnt(0)
    v_bitop3_b32 v11, v11, v95, s34 bitop3:0xf6
    v_cmp_ne_u32 vcc, 0, v11
    s_cbranch_vccz L_pdone_30
    s_sub_u32 s64, s64, 1
    s_cmp_lg_u32 s64, 0
    s_cbranch_scc1 L_poll_29
L_pdone_30:
    v_pk_add_f32 v[64:65], v[64:65], v[68:69]
    v_pk_add_f32 v[72:73], v[72:73], v[76:77]
    v_pk_add_f32 v[64:65], v[64:65], v[72:73]
    v_pk_add_f32 v[80:81], v[80:81], v[84:85]
    v_pk_add_f32 v[88:89], v[88:89], v[92:93]
    v_pk_add_f32 v[80:81], v[80:81], v[88:89]
    v_cvt_pk_bf16_f32 v65, v64, v65
    v_lshlrev_b32 v64, 16, v65
    v_and_b32 v65, 0xffff0000, v65
    v_cvt_pk_bf16_f32 v81, v80, v81
    v_lshlrev_b32 v80, 16, v81
    v_and_b32 v81, 0xffff0000, v81
    v_add_f32 v80, 1.0, v80
    v_add_f32 v81, 1.0, v81
    v_cvt_pk_bf16_f32 v81, v80, v81
    v_lshlrev_b32 v80, 16, v81
    v_and_b32 v81, 0xffff0000, v81
    v_mul_f32 v24, v24, v80
    v_mul_f32 v25, v25, v81
    v_cvt_pk_bf16_f32 v25, v24, v25
    v_lshlrev_b32 v24, 16, v25
    v_and_b32 v25, 0xffff0000, v25
    v_add_f32 v24, v24, v64
    v_add_f32 v25, v25, v65
    v_cvt_pk_bf16_f32 v24, v24, v24
    v_cvt_pk_bf16_f32 v25, v25, v25
    s_nop 0
    v_and_b32_dpp v32, v24, v16 row_newbcast:0 row_mask:0xf bank_mask:0xf
    v_and_b32_dpp v33, v24, v17 row_newbcast:0 row_mask:0xf bank_mask:0xf
    v_and_b32_dpp v34, v24, v18 row_newbcast:0 row_mask:0xf bank_mask:0xf
    v_and_b32_dpp v35, v24, v19 row_newbcast:0 row_mask:0xf bank_mask:0xf
    v_and_b32_dpp v36, v24, v16 row_newbcast:1 row_mask:0xf bank_mask:0xf
    v_and_b32_dpp v37, v24, v17 row_newbcast:1 row_mask:0xf bank_mask:0xf
    v_and_b32_dpp v38, v24, v18 row_newbcast:1 row_mask:0xf bank_mask:0xf
    v_and_b32_dpp v39, v24, v19 row_newbcast:1 row_mask:0xf bank_mask:0xf
    v_mfma_f32_16x16x32_bf16 v[20:23], v[32:35], v[128:131], 0
    v_and_b32_dpp v40, v24, v16 row_newbcast:2 row_mask:0xf bank_mask:0xf
    v_and_b32_dpp v41, v24, v17 row_newbcast:2 row_mask:0xf bank_mask:0xf
    v_and_b32_dpp v42, v24, v18 row_newbcast:2 row_mask:0xf bank_mask:0xf
    v_and_b32_dpp v43, v24, v19 row_newbcast:2 row_mask:0xf bank_mask:0xf
    v_mfma_f32_16x16x32_bf16 v[20:23], v[36:39], v[132:135], v[20:23]
    v_and_b32_dpp v44, v24, v16 row_newbcast:3 row_mask:0xf bank_mask:0xf
    v_and_b32_dpp v45, v24, v17 row_newbcast:3 row_mask:0xf bank_mask:0xf
    v_and_b32_dpp v46, v24, v18 row_newbcast:3 row_mask:0xf bank_mask:0xf
    v_and_b32_dpp v47, v24, v19 row_newbcast:3 row_mask:0xf bank_mask:0xf
    v_mfma_f32_16x16x32_bf16 v[20:23], v[40:43], v[136:139], v[20:23]
    v_and_b32_dpp v32, v24, v16 row_newbcast:4 row_mask:0xf bank_mask:0xf
    v_and_b32_dpp v33, v24, v17 row_newbcast:4 row_mask:0xf bank_mask:0xf
    v_and_b32_dpp v34, v24, v18 row_newbcast:4 row_mask:0xf bank_mask:0xf
    v_and_b32_dpp v35, v24, v19 row_newbcast:4 row_mask:0xf bank_mask:0xf
    v_mfma_f32_16x16x32_bf16 v[20:23], v[44:47], v[140:143], v[20:23]
    v_and_b32_dpp v36, v24, v16 row_newbcast:5 row_mask:0xf bank_mask:0xf
    v_and_b32_dpp v37, v24, v17 row_newbcast:5 row_mask:0xf bank_mask:0xf
    v_and_b32_dpp v38, v24, v18 row_newbcast:5 row_mask:0xf bank_mask:0xf
    v_and_b32_dpp v39, v24, v19 row_newbcast:5 row_mask:0xf bank_mask:0xf
    v_mfma_f32_16x16x32_bf16 v[20:23], v[32:35], v[144:147], v[20:23]
    v_and_b32_dpp v40, v24, v16 row_newbcast:6 row_mask:0xf bank_mask:0xf
    v_and_b32_dpp v41, v24, v17 row_newbcast:6 row_mask:0xf bank_mask:0xf
    v_and_b32_dpp v42, v24, v18 row_newbcast:6 row_mask:0xf bank_mask:0xf
    v_and_b32_dpp v43, v24, v19 row_newbcast:6 row_mask:0xf bank_mask:0xf
    v_mfma_f32_16x16x32_bf16 v[20:23], v[36:39], v[148:151], v[20:23]
    v_and_b32_dpp v44, v24, v16 row_newbcast:7 row_mask:0xf bank_mask:0xf
    v_and_b32_dpp v45, v24, v17 row_newbcast:7 row_mask:0xf bank_mask:0xf
    v_and_b32_dpp v46, v24, v18 row_newbcast:7 row_mask:0xf bank_mask:0xf
    v_and_b32_dpp v47, v24, v19 row_newbcast:7 row_mask:0xf bank_mask:0xf
    v_mfma_f32_16x16x32_bf16 v[20:23], v[40:43], v[152:155], v[20:23]
    v_and_b32_dpp v32, v24, v16 row_newbcast:8 row_mask:0xf bank_mask:0xf
    v_and_b32_dpp v33, v24, v17 row_newbcast:8 row_mask:0xf bank_mask:0xf
    v_and_b32_dpp v34, v24, v18 row_newbcast:8 row_mask:0xf bank_mask:0xf
    v_and_b32_dpp v35, v24, v19 row_newbcast:8 row_mask:0xf bank_mask:0xf
    v_mfma_f32_16x16x32_bf16 v[20:23], v[44:47], v[156:159], v[20:23]
    v_and_b32_dpp v36, v24, v16 row_newbcast:9 row_mask:0xf bank_mask:0xf
    v_and_b32_dpp v37, v24, v17 row_newbcast:9 row_mask:0xf bank_mask:0xf
    v_and_b32_dpp v38, v24, v18 row_newbcast:9 row_mask:0xf bank_mask:0xf
    v_and_b32_dpp v39, v24, v19 row_newbcast:9 row_mask:0xf bank_mask:0xf
    v_mfma_f32_16x16x32_bf16 v[20:23], v[32:35], v[160:163], v[20:23]
    v_and_b32_dpp v40, v24, v16 row_newbcast:10 row_mask:0xf bank_mask:0xf
    v_and_b32_dpp v41, v24, v17 row_newbcast:10 row_mask:0xf bank_mask:0xf
    v_and_b32_dpp v42, v24, v18 row_newbcast:10 row_mask:0xf bank_mask:0xf
    v_and_b32_dpp v43, v24, v19 row_newbcast:10 row_mask:0xf bank_mask:0xf
    v_mfma_f32_16x16x32_bf16 v[20:23], v[36:39], v[164:167], v[20:23]
    v_and_b32_dpp v44, v24, v16 row_newbcast:11 row_mask:0xf bank_mask:0xf
    v_and_b32_dpp v45, v24, v17 row_newbcast:11 row_mask:0xf bank_mask:0xf
    v_and_b32_dpp v46, v24, v18 row_newbcast:11 row_mask:0xf bank_mask:0xf
    v_and_b32_dpp v47, v24, v19 row_newbcast:11 row_mask:0xf bank_mask:0xf
    v_mfma_f32_16x16x32_bf16 v[20:23], v[40:43], v[168:171], v[20:23]
    v_and_b32_dpp v32, v24, v16 row_newbcast:12 row_mask:0xf bank_mask:0xf
    v_and_b32_dpp v33, v24, v17 row_newbcast:12 row_mask:0xf bank_mask:0xf
    v_and_b32_dpp v34, v24, v18 row_newbcast:12 row_mask:0xf bank_mask:0xf
    v_and_b32_dpp v35, v24, v19 row_newbcast:12 row_mask:0xf bank_mask:0xf
    v_mfma_f32_16x16x32_bf16 v[20:23], v[44:47], v[172:175], v[20:23]
    v_and_b32_dpp v36, v24, v16 row_newbcast:13 row_mask:0xf bank_mask:0xf
    v_and_b32_dpp v37, v24, v17 row_newbcast:13 row_mask:0xf bank_mask:0xf
    v_and_b32_dpp v38, v24, v18 row_newbcast:13 row_mask:0xf bank_mask:0xf
    v_and_b32_dpp v39, v24, v19 row_newbcast:13 row_mask:0xf bank_mask:0xf
    v_mfma_f32_16x16x32_bf16 v[20:23], v[32:35], v[176:179], v[20:23]
    v_and_b32_dpp v40, v24, v16 row_newbcast:14 row_mask:0xf bank_mask:0xf
    v_and_b32_dpp v41, v24, v17 row_newbcast:14 row_mask:0xf bank_mask:0xf
    v_and_b32_dpp v42, v24, v18 row_newbcast:14 row_mask:0xf bank_mask:0xf
    v_and_b32_dpp v43, v24, v19 row_newbcast:14 row_mask:0xf bank_mask:0xf
    v_mfma_f32_16x16x32_bf16 v[20:23], v[36:39], v[180:183], v[20:23]
    v_and_b32_dpp v44, v24, v16 row_newbcast:15 row_mask:0xf bank_mask:0xf
    v_and_b32_dpp v45, v24, v17 row_newbcast:15 row_mask:0xf bank_mask:0xf
    v_and_b32_dpp v46, v24, v18 row_newbcast:15 row_mask:0xf bank_mask:0xf
    v_and_b32_dpp v47, v24, v19 row_newbcast:15 row_mask:0xf bank_mask:0xf
    v_mfma_f32_16x16x32_bf16 v[20:23], v[40:43], v[184:187], v[20:23]
    v_and_b32_dpp v32, v25, v16 row_newbcast:0 row_mask:0xf bank_mask:0xf
    v_and_b32_dpp v33, v25, v17 row_newbcast:0 row_mask:0xf bank_mask:0xf
    v_and_b32_dpp v34, v25, v18 row_newbcast:0 row_mask:0xf bank_mask:0xf
    v_and_b32_dpp v35, v25, v19 row_newbcast:0 row_mask:0xf bank_mask:0xf
    v_mfma_f32_16x16x32_bf16 v[20:23], v[44:47], v[188:191], v[20:23]
    v_and_b32_dpp v36, v25, v16 row_newbcast:1 row_mask:0xf bank_mask:0xf
    v_and_b32_dpp v37, v25, v17 row_newbcast:1 row_mask:0xf bank_mask:0xf
    v_and_b32_dpp v38, v25, v18 row_newbcast:1 row_mask:0xf bank_mask:0xf
    v_and_b32_dpp v39, v25, v19 row_newbcast:1 row_mask:0xf bank_mask:0xf
    v_mfma_f32_16x16x32_bf16 v[20:23], v[32:35], v[192:195], v[20:23]
    v_and_b32_dpp v40, v25, v16 row_newbcast:2 row_mask:0xf bank_mask:0xf
    v_and_b32_dpp v41, v25, v17 row_newbcast:2 row_mask:0xf bank_mask:0xf
    v_and_b32_dpp v42, v25, v18 row_newbcast:2 row_mask:0xf bank_mask:0xf
    v_and_b32_dpp v43, v25, v19 row_newbcast:2 row_mask:0xf bank_mask:0xf
    v_mfma_f32_16x16x32_bf16 v[20:23], v[36:39], v[196:199], v[20:23]
    v_and_b32_dpp v44, v25, v16 row_newbcast:3 row_mask:0xf bank_mask:0xf
    v_and_b32_dpp v45, v25, v17 row_newbcast:3 row_mask:0xf bank_mask:0xf
    v_and_b32_dpp v46, v25, v18 row_newbcast:3 row_mask:0xf bank_mask:0xf
    v_and_b32_dpp v47, v25, v19 row_newbcast:3 row_mask:0xf bank_mask:0xf
    v_mfma_f32_16x16x32_bf16 v[20:23], v[40:43], v[200:203], v[20:23]
    v_and_b32_dpp v32, v25, v16 row_newbcast:4 row_mask:0xf bank_mask:0xf
    v_and_b32_dpp v33, v25, v17 row_newbcast:4 row_mask:0xf bank_mask:0xf
    v_and_b32_dpp v34, v25, v18 row_newbcast:4 row_mask:0xf bank_mask:0xf
    v_and_b32_dpp v35, v25, v19 row_newbcast:4 row_mask:0xf bank_mask:0xf
    v_mfma_f32_16x16x32_bf16 v[20:23], v[44:47], v[204:207], v[20:23]
    v_and_b32_dpp v36, v25, v16 row_newbcast:5 row_mask:0xf bank_mask:0xf
    v_and_b32_dpp v37, v25, v17 row_newbcast:5 row_mask:0xf bank_mask:0xf
    v_and_b32_dpp v38, v25, v18 row_newbcast:5 row_mask:0xf bank_mask:0xf
    v_and_b32_dpp v39, v25, v19 row_newbcast:5 row_mask:0xf bank_mask:0xf
    v_mfma_f32_16x16x32_bf16 v[20:23], v[32:35], v[208:211], v[20:23]
    v_and_b32_dpp v40, v25, v16 row_newbcast:6 row_mask:0xf bank_mask:0xf
    v_and_b32_dpp v41, v25, v17 row_newbcast:6 row_mask:0xf bank_mask:0xf
    v_and_b32_dpp v42, v25, v18 row_newbcast:6 row_mask:0xf bank_mask:0xf
    v_and_b32_dpp v43, v25, v19 row_newbcast:6 row_mask:0xf bank_mask:0xf
    v_mfma_f32_16x16x32_bf16 v[20:23], v[36:39], v[212:215], v[20:23]
    v_and_b32_dpp v44, v25, v16 row_newbcast:7 row_mask:0xf bank_mask:0xf
    v_and_b32_dpp v45, v25, v17 row_newbcast:7 row_mask:0xf bank_mask:0xf
    v_and_b32_dpp v46, v25, v18 row_newbcast:7 row_mask:0xf bank_mask:0xf
    v_and_b32_dpp v47, v25, v19 row_newbcast:7 row_mask:0xf bank_mask:0xf
    v_mfma_f32_16x16x32_bf16 v[20:23], v[40:43], v[216:219], v[20:23]
    v_and_b32_dpp v32, v25, v16 row_newbcast:8 row_mask:0xf bank_mask:0xf
    v_and_b32_dpp v33, v25, v17 row_newbcast:8 row_mask:0xf bank_mask:0xf
    v_and_b32_dpp v34, v25, v18 row_newbcast:8 row_mask:0xf bank_mask:0xf
    v_and_b32_dpp v35, v25, v19 row_newbcast:8 row_mask:0xf bank_mask:0xf
    v_mfma_f32_16x16x32_bf16 v[20:23], v[44:47], v[220:223], v[20:23]
    v_and_b32_dpp v36, v25, v16 row_newbcast:9 row_mask:0xf bank_mask:0xf
    v_and_b32_dpp v37, v25, v17 row_newbcast:9 row_mask:0xf bank_mask:0xf
    v_and_b32_dpp v38, v25, v18 row_newbcast:9 row_mask:0xf bank_mask:0xf
    v_and_b32_dpp v39, v25, v19 row_newbcast:9 row_mask:0xf bank_mask:0xf
    v_mfma_f32_16x16x32_bf16 v[20:23], v[32:35], v[224:227], v[20:23]
    v_and_b32_dpp v40, v25, v16 row_newbcast:10 row_mask:0xf bank_mask:0xf
    v_and_b32_dpp v41, v25, v17 row_newbcast:10 row_mask:0xf bank_mask:0xf
    v_and_b32_dpp v42, v25, v18 row_newbcast:10 row_mask:0xf bank_mask:0xf
    v_and_b32_dpp v43, v25, v19 row_newbcast:10 row_mask:0xf bank_mask:0xf
    v_mfma_f32_16x16x32_bf16 v[20:23], v[36:39], v[228:231], v[20:23]
    v_and_b32_dpp v44, v25, v16 row_newbcast:11 row_mask:0xf bank_mask:0xf
    v_and_b32_dpp v45, v25, v17 row_newbcast:11 row_mask:0xf bank_mask:0xf
    v_and_b32_dpp v46, v25, v18 row_newbcast:11 row_mask:0xf bank_mask:0xf
    v_and_b32_dpp v47, v25, v19 row_newbcast:11 row_mask:0xf bank_mask:0xf
    v_mfma_f32_16x16x32_bf16 v[20:23], v[40:43], v[232:235], v[20:23]
    v_and_b32_dpp v32, v25, v16 row_newbcast:12 row_mask:0xf bank_mask:0xf
    v_and_b32_dpp v33, v25, v17 row_newbcast:12 row_mask:0xf bank_mask:0xf
    v_and_b32_dpp v34, v25, v18 row_newbcast:12 row_mask:0xf bank_mask:0xf
    v_and_b32_dpp v35, v25, v19 row_newbcast:12 row_mask:0xf bank_mask:0xf
    v_mfma_f32_16x16x32_bf16 v[20:23], v[44:47], v[236:239], v[20:23]
    v_and_b32_dpp v36, v25, v16 row_newbcast:13 row_mask:0xf bank_mask:0xf
    v_and_b32_dpp v37, v25, v17 row_newbcast:13 row_mask:0xf bank_mask:0xf
    v_and_b32_dpp v38, v25, v18 row_newbcast:13 row_mask:0xf bank_mask:0xf
    v_and_b32_dpp v39, v25, v19 row_newbcast:13 row_mask:0xf bank_mask:0xf
    v_mfma_f32_16x16x32_bf16 v[20:23], v[32:35], v[240:243], v[20:23]
    v_and_b32_dpp v40, v25, v16 row_newbcast:14 row_mask:0xf bank_mask:0xf
    v_and_b32_dpp v41, v25, v17 row_newbcast:14 row_mask:0xf bank_mask:0xf
    v_and_b32_dpp v42, v25, v18 row_newbcast:14 row_mask:0xf bank_mask:0xf
    v_and_b32_dpp v43, v25, v19 row_newbcast:14 row_mask:0xf bank_mask:0xf
    v_mfma_f32_16x16x32_bf16 v[20:23], v[36:39], v[244:247], v[20:23]
    v_and_b32_dpp v44, v25, v16 row_newbcast:15 row_mask:0xf bank_mask:0xf
    v_and_b32_dpp v45, v25, v17 row_newbcast:15 row_mask:0xf bank_mask:0xf
    v_and_b32_dpp v46, v25, v18 row_newbcast:15 row_mask:0xf bank_mask:0xf
    v_and_b32_dpp v47, v25, v19 row_newbcast:15 row_mask:0xf bank_mask:0xf
    v_mfma_f32_16x16x32_bf16 v[20:23], v[40:43], v[248:251], v[20:23]
    s_nop 0
    v_mfma_f32_16x16x32_bf16 v[20:23], v[44:47], v[252:255], v[20:23]
    v_lshlrev_b32 v48, 3, v9
    s_cmp_eq_u32 s3, 0
    s_cbranch_scc1 L_qsum
    s_lshl_b32 s68, s3, 9
    v_add_u32 v48, s68, v48
    s_nop 2
    ds_write_b64 v48, v[20:21] offset:1024
    s_waitcnt lgkmcnt(0)
    s_mov_b64 exec, 1
    ds_add_u32 v2, v3 offset:24
    s_mov_b64 exec, -1
    s_setprio 0
    s_cmp_eq_u32 s3, 7
    s_cbranch_scc1 L_soft
    s_branch L_help7
L_qsum:
    s_mov_b32 s64, 0x400000
L_lw_31:
    ds_read_b32 v11, v2 offset:24
    s_sub_u32 s64, s64, 1
    s_cmp_eq_u32 s64, 0
    s_cbranch_scc1 L_lwd_32
    s_waitcnt lgkmcnt(0)
    v_cmp_gt_u32 vcc, 2, v11
    s_cbranch_vccnz L_lw_31
L_lwd_32:
    ds_read_b64 v[64:65], v48 offset:4096
    ds_read_b64 v[66:67], v48 offset:4608
    s_lshl_b32 s68, s38, 1
    s_add_u32 s68, s68, s37
    s_lshl_b32 s68, s68, 10
    s_add_u32 s68, s68, 45056
    s_waitcnt lgkmcnt(0)
    v_pk_add_f32 v[20:21], v[20:21], v[64:65]
    v_pk_add_f32 v[20:21], v[20:21], v[66:67]
    v_mov_b32 v23, s34
    buffer_store_dwordx4 v[20:23], v1, s[48:51], s68 offen sc1
L_hop2:
    s_lshl_b32 s6, s32, 11
    s_add_u32 s6, s6, 45056
    s_add_u32 s68, s30, s6
    s_addc_u32 s69, s31, 0
    s_mov_b32 s64, 0x40000
L_spoll_33:
    s_load_dword s40, s[68:69], 1020 glc
    s_load_dword s41, s[68:69], 2044 glc
    s_sub_u32 s64, s64, 1
    s_cmp_eq_u32 s64, 0
    s_cbranch_scc1 L_spd_34
    s_waitcnt lgkmcnt(0)
    s_cmp_lg_u32 s40, s34
    s_cbranch_scc1 L_spoll_33
    s_cmp_lg_u32 s41, s34
    s_cbranch_scc1 L_spoll_33
L_spd_34:
    s_waitcnt lgkmcnt(0)
    s_mov_b32 s64, 0x40000
L_poll_35:
    buffer_load_dwordx4 v[64:67], v1, s[48:51], s6 offen offset:0 sc1
    buffer_load_dwordx4 v[68:71], v1, s[48:51], s6 offen offset:1024 sc1
    s_waitcnt vmcnt(1)
    v_xor_b32 v11, s34, v67
    s_waitcnt vmcnt(0)
    v_bitop3_b32 v11, v11, v71, s34 bitop3:0xf6
    v_cmp_ne_u32 vcc, 0, v11
    s_cbranch_vccz L_pdone_36
    s_sub_u32 s64, s64, 1
    s_cmp_lg_u32 s64, 0
    s_cbranch_scc1 L_poll_35
L_pdone_36:
    v_pk_add_f32 v[64:65], v[64:65], v[68:69]
    v_cvt_pk_bf16_f32 v64, v64, v65
    v_lshrrev_b32 v48, 2, v10
    ds_write_b32 v48, v64 offset:256
    s_waitcnt lgkmcnt(0)
    ds_write_b32 v2, v3 offset:8
    s_setprio 0
L_ctrl_w:
    s_cmp_ge_u32 s65, 54
    s_cbranch_scc1 L_cnomr
    s_mov_b32 s56, s4
    s_mov_b32 s57, s5
    s_mov_b32 s58, 1280
    s_mov_b32 s59, 0x20000
    v_lshlrev_b32 v48, 2, v9
    v_lshlrev_b32 v49, 3, v9
    buffer_load_dword v33, v48, s[56:59], 0 offen offset:0
    buffer_load_dword v35, v48, s[56:59], 0 offen offset:256
    buffer_load_dword v37, v48, s[56:59], 0 offen offset:512
    buffer_load_dword v39, v48, s[56:59], 0 offen offset:768
    buffer_load_dword v41, v48, s[56:59], 0 offen offset:1024
    s_waitcnt vmcnt(0)
    v_lshlrev_b32 v32, 16, v33
    v_and_b32 v33, 0xffff0000, v33
    ds_write_b64 v49, v[32:33] offset:8192
    v_lshlrev_b32 v34, 16, v35
    v_and_b32 v35, 0xffff0000, v35
    ds_write_b64 v49, v[34:35] offset:8704
    v_lshlrev_b32 v36, 16, v37
    v_and_b32 v37, 0xffff0000, v37
    ds_write_b64 v49, v[36:37] offset:9216
    v_lshlrev_b32 v38, 16, v39
    v_and_b32 v39, 0xffff0000, v39
    ds_write_b64 v49, v[38:39] offset:9728
    v_lshlrev_b32 v40, 16, v41
    v_and_b32 v41, 0xffff0000, v41
    ds_write_b64 v49, v[40:41] offset:10240
    v_lshrrev_b32 v49, 1, v10
    s_mov_b32 s40, 372736
    s_mov_b32 s41, 376832
    s_mov_b32 s42, 393216
    s_mov_b32 s43, 397312
    s_mov_b32 s64, 0x40000
L_poll_37:
    buffer_load_dwordx4 v[64:67], v1, s[48:51], s40 offen offset:0 sc1
    buffer_load_dwordx4 v[68:71], v1, s[48:51], s42 offen offset:0 sc1
    buffer_load_dwordx4 v[72:75], v1, s[48:51], s40 offen offset:1024 sc1
    buffer_load_dwordx4 v[76:79], v1, s[48:51], s42 offen offset:1024 sc1
    buffer_load_dwordx4 v[80:83], v1, s[48:51], s40 offen offset:2048 sc1
    buffer_load_dwordx4 v[84:87], v1, s[48:51], s42 offen offset:2048 sc1
    buffer_load_dwordx4 v[88:91], v1, s[48:51], s40 offen offset:3072 sc1
    buffer_load_dwordx4 v[92:95], v1, s[48:51], s42 offen offset:3072 sc1
    buffer_load_dwordx4 v[96:99], v1, s[48:51], s41 offen offset:0 sc1
    buffer_load_dwordx4 v[100:103], v1, s[48:51], s43 offen offset:0 sc1
    s_waitcnt vmcnt(9)
    v_xor_b32 v11, s34, v67
    s_waitcnt vmcnt(8)
    v_bitop3_b32 v11, v11, v71, s34 bitop3:0xf6
    s_waitcnt vmcnt(7)
    v_bitop3_b32 v11, v11, v75, s34 bitop3:0xf6
    s_waitcnt vmcnt(6)
    v_bitop3_b32 v11, v11, v79, s34 bitop3:0xf6
    s_waitcnt vmcnt(5)
    v_bitop3_b32 v11, v11, v83, s34 bitop3:0xf6
    s_waitcnt vmcnt(4)
    v_bitop3_b32 v11, v11, v87, s34 bitop3:0xf6
    s_waitcnt vmcnt(3)
    v_bitop3_b32 v11, v11, v91, s34 bitop3:0xf6
    s_waitcnt vmcnt(2)
    v_bitop3_b32 v11, v11, v95, s34 bitop3:0xf6
    s_waitcnt vmcnt(1)
    v_bitop3_b32 v11, v11, v99, s34 bitop3:0xf6
    s_waitcnt vmcnt(0)
    v_bitop3_b32 v11, v11, v103, s34 bitop3:0xf6
    v_cmp_ne_u32 vcc, 0, v11
    s_cbranch_vccz L_pdone_38
    s_sub_u32 s64, s64, 1
    s_cmp_lg_u32 s64, 0
    s_cbranch_scc1 L_poll_37
L_pdone_38:
    v_pk_add_f32 v[64:65], v[64:65], v[68:69]
    v_cvt_pk_bf16_f32 v65, v64, v65
    v_lshlrev_b32 v64, 16, v65
    v_and_b32 v65, 0xffff0000, v65
    ds_write_b64 v49, v[64:65] offset:20480
    v_pk_add_f32 v[72:73], v[72:73], v[76:77]
    v_cvt_pk_bf16_f32 v73, v72, v73
    v_lshlrev_b32 v72, 16, v73
    v_and_b32 v73, 0xffff0000, v73
    ds_write_b64 v49, v[72:73] offset:20992
    v_pk_add_f32 v[80:81], v[80:81], v[84:85]
    v_cvt_pk_bf16_f32 v81, v80, v81
    v_lshlrev_b32 v80, 16, v81
    v_and_b32 v81, 0xffff0000, v81
    ds_write_b64 v49, v[80:81] offset:21504
    v_pk_add_f32 v[88:89], v[88:89], v[92:93]
    v_cvt_pk_bf16_f32 v89, v88, v89
    v_lshlrev_b32 v88, 16, v89
    v_and_b32 v89, 0xffff0000, v89
    ds_write_b64 v49, v[88:89] offset:22016
    v_pk_add_f32 v[96:97], v[96:97], v[100:101]
    v_cvt_pk_bf16_f32 v97, v96, v97
    v_lshlrev_b32 v96, 16, v97
    v_and_b32 v97, 0xffff0000, v97
    ds_write_b64 v49, v[96:97] offset:22528
    s_mov_b32 s40, 377856
    s_mov_b32 s41, 381952
    s_mov_b32 s42, 398336
    s_mov_b32 s43, 402432
    s_mov_b32 s64, 0x40000
L_poll_39:
    buffer_load_dwordx4 v[64:67], v1, s[48:51], s40 offen offset:0 sc1
    buffer_load_dwordx4 v[68:71], v1, s[48:51], s42 offen offset:0 sc1
    buffer_load_dwordx4 v[72:75], v1, s[48:51], s40 offen offset:1024 sc1
    buffer_load_dwordx4 v[76:79], v1, s[48:51], s42 offen offset:1024 sc1
    buffer_load_dwordx4 v[80:83], v1, s[48:51], s40 offen offset:2048 sc1
    buffer_load_dwordx4 v[84:87], v1, s[48:51], s42 offen offset:2048 sc1
    buffer_load_dwordx4 v[88:91], v1, s[48:51], s40 offen offset:3072 sc1
    buffer_load_dwordx4 v[92:95], v1, s[48:51], s42 offen offset:3072 sc1
    buffer_load_dwordx4 v[96:99], v1, s[48:51], s41 offen offset:0 sc1
    buffer_load_dwordx4 v[100:103], v1, s[48:51], s43 offen offset:0 sc1
    s_waitcnt vmcnt(9)
    v_xor_b32 v11, s34, v67
    s_waitcnt vmcnt(8)
    v_bitop3_b32 v11, v11, v71, s34 bitop3:0xf6
    s_waitcnt vmcnt(7)
    v_bitop3_b32 v11, v11, v75, s34 bitop3:0xf6
    s_waitcnt vmcnt(6)
    v_bitop3_b32 v11, v11, v79, s34 bitop3:0xf6
    s_waitcnt vmcnt(5)
    v_bitop3_b32 v11, v11, v83, s34 bitop3:0xf6
    s_waitcnt vmcnt(4)
    v_bitop3_b32 v11, v11, v87, s34 bitop3:0xf6
    s_waitcnt vmcnt(3)
    v_bitop3_b32 v11, v11, v91, s34 bitop3:0xf6
    s_waitcnt vmcnt(2)
    v_bitop3_b32 v11, v11, v95, s34 bitop3:0xf6
    s_waitcnt vmcnt(1)
    v_bitop3_b32 v11, v11, v99, s34 bitop3:0xf6
    s_waitcnt vmcnt(0)
    v_bitop3_b32 v11, v11, v103, s34 bitop3:0xf6
    v_cmp_ne_u32 vcc, 0, v11
    s_cbranch_vccz L_pdone_40
    s_sub_u32 s64, s64, 1
    s_cmp_lg_u32 s64, 0
    s_cbranch_scc1 L_poll_39
L_pdone_40:
    v_pk_add_f32 v[64:65], v[64:65], v[68:69]
    v_cvt_pk_bf16_f32 v65, v64, v65
    v_lshlrev_b32 v64, 16, v65
    v_and_b32 v65, 0xffff0000, v65
    ds_write_b64 v49, v[64:65] offset:23040
    v_pk_add_f32 v[72:73], v[72:73], v[76:77]
    v_cvt_pk_bf16_f32 v73, v72, v73
    v_lshlrev_b32 v72, 16, v73
    v_and_b32 v73, 0xffff0000, v73
    ds_write_b64 v49, v[72:73] offset:23552
    v_pk_add_f32 v[80:81], v[80:81], v[84:85]
    v_cvt_pk_bf16_f32 v81, v80, v81
    v_lshlrev_b32 v80, 16, v81
    v_and_b32 v81, 0xffff0000, v81
    ds_write_b64 v49, v[80:81] offset:24064
    v_pk_add_f32 v[88:89], v[88:89], v[92:93]
    v_cvt_pk_bf16_f32 v89, v88, v89
    v_lshlrev_b32 v88, 16, v89
    v_and_b32 v89, 0xffff0000, v89
    ds_write_b64 v49, v[88:89] offset:24576
    v_pk_add_f32 v[96:97], v[96:97], v[100:101]
    v_cvt_pk_bf16_f32 v97, v96, v97
    v_lshlrev_b32 v96, 16, v97
    v_and_b32 v97, 0xffff0000, v97
    ds_write_b64 v49, v[96:97] offset:25088
    s_mov_b32 s40, 382976
    s_mov_b32 s41, 387072
    s_mov_b32 s42, 403456
    s_mov_b32 s43, 407552
    s_mov_b32 s64, 0x40000
L_poll_41:
    buffer_load_dwordx4 v[64:67], v1, s[48:51], s40 offen offset:0 sc1
    buffer_load_dwordx4 v[68:71], v1, s[48:51], s42 offen offset:0 sc1
    buffer_load_dwordx4 v[72:75], v1, s[48:51], s40 offen offset:1024 sc1
    buffer_load_dwordx4 v[76:79], v1, s[48:51], s42 offen offset:1024 sc1
    buffer_load_dwordx4 v[80:83], v1, s[48:51], s40 offen offset:2048 sc1
    buffer_load_dwordx4 v[84:87], v1, s[48:51], s42 offen offset:2048 sc1
    buffer_load_dwordx4 v[88:91], v1, s[48:51], s40 offen offset:3072 sc1
    buffer_load_dwordx4 v[92:95], v1, s[48:51], s42 offen offset:3072 sc1
    buffer_load_dwordx4 v[96:99], v1, s[48:51], s41 offen offset:0 sc1
    buffer_load_dwordx4 v[100:103], v1, s[48:51], s43 offen offset:0 sc1
    s_waitcnt vmcnt(9)
    v_xor_b32 v11, s34, v67
    s_waitcnt vmcnt(8)
    v_bitop3_b32 v11, v11, v71, s34 bitop3:0xf6
    s_waitcnt vmcnt(7)
    v_bitop3_b32 v11, v11, v75, s34 bitop3:0xf6
    s_waitcnt vmcnt(6)
    v_bitop3_b32 v11, v11, v79, s34 bitop3:0xf6
    s_waitcnt vmcnt(5)
    v_bitop3_b32 v11, v11, v83, s34 bitop3:0xf6
    s_waitcnt vmcnt(4)
    v_bitop3_b32 v11, v11, v87, s34 bitop3:0xf6
    s_waitcnt vmcnt(3)
    v_bitop3_b32 v11, v11, v91, s34 bitop3:0xf6
    s_waitcnt vmcnt(2)
    v_bitop3_b32 v11, v11, v95, s34 bitop3:0xf6
    s_waitcnt vmcnt(1)
    v_bitop3_b32 v11, v11, v99, s34 bitop3:0xf6
    s_waitcnt vmcnt(0)
    v_bitop3_b32 v11, v11, v103, s34 bitop3:0xf6
    v_cmp_ne_u32 vcc, 0, v11
    s_cbranch_vccz L_pdone_42
    s_sub_u32 s64, s64, 1
    s_cmp_lg_u32 s64, 0
    s_cbranch_scc1 L_poll_41
L_pdone_42:
    v_pk_add_f32 v[64:65], v[64:65], v[68:69]
    v_cvt_pk_bf16_f32 v65, v64, v65
    v_lshlrev_b32 v64, 16, v65
    v_and_b32 v65, 0xffff0000, v65
    v_add_f32 v64, 1.0, v64
    v_add_f32 v65, 1.0, v65
    v_cvt_pk_bf16_f32 v65, v64, v65
    v_lshlrev_b32 v64, 16, v65
    v_and_b32 v65, 0xffff0000, v65
    ds_write_b64 v49, v[64:65] offset:25600
    v_pk_add_f32 v[72:73], v[72:73], v[76:77]
    v_cvt_pk_bf16_f32 v73, v72, v73
    v_lshlrev_b32 v72, 16, v73
    v_and_b32 v73, 0xffff0000, v73
    v_add_f32 v72, 1.0, v72
    v_add_f32 v73, 1.0, v73
    v_cvt_pk_bf16_f32 v73, v72, v73
    v_lshlrev_b32 v72, 16, v73
    v_and_b32 v73, 0xffff0000, v73
    ds_write_b64 v49, v[72:73] offset:26112
    v_pk_add_f32 v[80:81], v[80:81], v[84:85]
    v_cvt_pk_bf16_f32 v81, v80, v81
    v_lshlrev_b32 v80, 16, v81
    v_and_b32 v81, 0xffff0000, v81
    v_add_f32 v80, 1.0, v80
    v_add_f32 v81, 1.0, v81
    v_cvt_pk_bf16_f32 v81, v80, v81
    v_lshlrev_b32 v80, 16, v81
    v_and_b32 v81, 0xffff0000, v81
    ds_write_b64 v49, v[80:81] offset:26624
    v_pk_add_f32 v[88:89], v[88:89], v[92:93]
    v_cvt_pk_bf16_f32 v89, v88, v89
    v_lshlrev_b32 v88, 16, v89
    v_and_b32 v89, 0xffff0000, v89
    v_add_f32 v88, 1.0, v88
    v_add_f32 v89, 1.0, v89
    v_cvt_pk_bf16_f32 v89, v88, v89
    v_lshlrev_b32 v88, 16, v89
    v_and_b32 v89, 0xffff0000, v89
    ds_write_b64 v49, v[88:89] offset:27136
    v_pk_add_f32 v[96:97], v[96:97], v[100:101]
    v_cvt_pk_bf16_f32 v97, v96, v97
    v_lshlrev_b32 v96, 16, v97
    v_and_b32 v97, 0xffff0000, v97
    v_add_f32 v96, 1.0, v96
    v_add_f32 v97, 1.0, v97
    v_cvt_pk_bf16_f32 v97, v96, v97
    v_lshlrev_b32 v96, 16, v97
    v_and_b32 v97, 0xffff0000, v97
    ds_write_b64 v49, v[96:97] offset:27648
    s_mov_b32 s40, 388096
    s_mov_b32 s41, 392192
    s_mov_b32 s42, 408576
    s_mov_b32 s43, 412672
    s_mov_b32 s64, 0x40000
L_poll_43:
    buffer_load_dwordx4 v[64:67], v1, s[48:51], s40 offen offset:0 sc1
    buffer_load_dwordx4 v[68:71], v1, s[48:51], s42 offen offset:0 sc1
    buffer_load_dwordx4 v[72:75], v1, s[48:51], s40 offen offset:1024 sc1
    buffer_load_dwordx4 v[76:79], v1, s[48:51], s42 offen offset:1024 sc1
    buffer_load_dwordx4 v[80:83], v1, s[48:51], s40 offen offset:2048 sc1
    buffer_load_dwordx4 v[84:87], v1, s[48:51], s42 offen offset:2048 sc1
    buffer_load_dwordx4 v[88:91], v1, s[48:51], s40 offen offset:3072 sc1
    buffer_load_dwordx4 v[92:95], v1, s[48:51], s42 offen offset:3072 sc1
    buffer_load_dwordx4 v[96:99], v1, s[48:51], s41 offen offset:0 sc1
    buffer_load_dwordx4 v[100:103], v1, s[48:51], s43 offen offset:0 sc1
    s_waitcnt vmcnt(9)
    v_xor_b32 v11, s34, v67
    s_waitcnt vmcnt(8)
    v_bitop3_b32 v11, v11, v71, s34 bitop3:0xf6
    s_waitcnt vmcnt(7)
    v_bitop3_b32 v11, v11, v75, s34 bitop3:0xf6
    s_waitcnt vmcnt(6)
    v_bitop3_b32 v11, v11, v79, s34 bitop3:0xf6
    s_waitcnt vmcnt(5)
    v_bitop3_b32 v11, v11, v83, s34 bitop3:0xf6
    s_waitcnt vmcnt(4)
    v_bitop3_b32 v11, v11, v87, s34 bitop3:0xf6
    s_waitcnt vmcnt(3)
    v_bitop3_b32 v11, v11, v91, s34 bitop3:0xf6
    s_waitcnt vmcnt(2)
    v_bitop3_b32 v11, v11, v95, s34 bitop3:0xf6
    s_waitcnt vmcnt(1)
    v_bitop3_b32 v11, v11, v99, s34 bitop3:0xf6
    s_waitcnt vmcnt(0)
    v_bitop3_b32 v11, v11, v103, s34 bitop3:0xf6
    v_cmp_ne_u32 vcc, 0, v11
    s_cbranch_vccz L_pdone_44
    s_sub_u32 s64, s64, 1
    s_cmp_lg_u32 s64, 0
    s_cbranch_scc1 L_poll_43
L_pdone_44:
    v_pk_add_f32 v[64:65], v[64:65], v[68:69]
    v_cvt_pk_bf16_f32 v65, v64, v65
    v_lshlrev_b32 v64, 16, v65
    v_and_b32 v65, 0xffff0000, v65
    ds_write_b64 v49, v[64:65] offset:28160
    v_pk_add_f32 v[72:73], v[72:73], v[76:77]
    v_cvt_pk_bf16_f32 v73, v72, v73
    v_lshlrev_b32 v72, 16, v73
    v_and_b32 v73, 0xffff0000, v73
    ds_write_b64 v49, v[72:73] offset:28672
    v_pk_add_f32 v[80:81], v[80:81], v[84:85]
    v_cvt_pk_bf16_f32 v81, v80, v81
    v_lshlrev_b32 v80, 16, v81
    v_and_b32 v81, 0xffff0000, v81
    ds_write_b64 v49, v[80:81] offset:29184
    v_pk_add_f32 v[88:89], v[88:89], v[92:93]
    v_cvt_pk_bf16_f32 v89, v88, v89
    v_lshlrev_b32 v88, 16, v89
    v_and_b32 v89, 0xffff0000, v89
    ds_write_b64 v49, v[88:89] offset:29696
    v_pk_add_f32 v[96:97], v[96:97], v[100:101]
    v_cvt_pk_bf16_f32 v97, v96, v97
    v_lshlrev_b32 v96, 16, v97
    v_and_b32 v97, 0xffff0000, v97
    ds_write_b64 v49, v[96:97] offset:30208
L_cnomr:
    s_mov_b32 s64, 0x400000
L_lw_45:
    s_sleep 16
    ds_read_b32 v11, v2 offset:4
    s_sub_u32 s64, s64, 1
    s_cmp_eq_u32 s64, 0
    s_cbranch_scc1 L_lwd_46
    s_waitcnt lgkmcnt(0)
    v_cmp_gt_u32 vcc, 88, v11
    s_cbranch_vccnz L_lw_45
L_lwd_46:
    v_and_b32 v48, 7, v9
    v_lshlrev_b32 v48, 7, v48
    s_mov_b32 s40, 3932160
    s_mov_b32 s64, 0x40000
L_poll_47:
    buffer_load_dwordx4 v[64:67], v48, s[48:51], s40 offen offset:0 sc1
    s_waitcnt vmcnt(0)
    v_xor_b32 v11, s34, v67
    v_cmp_ne_u32 vcc, 0, v11
    s_cbranch_vccz L_pdone_48
    s_sub_u32 s64, s64, 1
    s_cmp_lg_u32 s64, 0
    s_cbranch_scc1 L_poll_47
L_pdone_48:
    v_cmp_ne_u32 vcc, 0, v64
    s_nop 1
    v_mov_b32 v48, vcc_lo
    v_and_b32 v48, 0xff, v48
    ds_write_b32 v2, v48 offset:36
    s_waitcnt lgkmcnt(0)
    ds_read_b32 v11, v2 offset:36
    s_waitcnt lgkmcnt(0)
    v_readfirstlane_b32 s28, v11
    s_and_b32 s68, s32, 7
    s_lshr_b32 s9, s28, s68
    s_and_b32 s9, s9, 1
    s_lshl_b32 s9, s9, 13
    s_lshl_b32 s8, s32, 4
    s_add_u32 s8, s8, s33
    s_lshl_b32 s8, s8, 10
    s_add_u32 s8, s8, s9
    s_add_u32 s8, s8, 2097152
    v_lshlrev_b32 v48, 3, v9
    v_mov_b32 v99, s34
    s_waitcnt vmcnt(0) lgkmcnt(0)
    s_barrier
    ds_read_b64 v[64:65], v48 offset:1024
    ds_read_b64 v[66:67], v48 offset:1536
    ds_read_b64 v[68:69], v48 offset:2048
    ds_read_b64 v[70:71], v48 offset:2560
    ds_read_b64 v[72:73], v48 offset:3072
    ds_read_b64 v[74:75], v48 offset:3584
    s_waitcnt lgkmcnt(0)
    v_pk_add_f32 v[64:65], v[64:65], v[66:67]
    v_pk_add_f32 v[68:69], v[68:69], v[70:71]
    v_pk_add_f32 v[72:73], v[72:73], v[74:75]
    v_pk_add_f32 v[64:65], v[64:65], v[68:69]
    v_pk_add_f32 v[96:97], v[64:65], v[72:73]
    buffer_store_dwordx4 v[96:99], v1, s[48:51], s8 offen sc1
    s_branch L_tail
L_end:
    s_endpgm
.section .rodata,"a"
.p2align 6
.amdhsa_kernel adaLN_cond__gqa_block_cached__swiglu_ffn__decode_kernel
.amdhsa_next_free_vgpr 256
.amdhsa_next_free_sgpr 100
.amdhsa_accum_offset 256
.amdhsa_group_segment_fixed_size 0
.amdhsa_kernarg_size 112
.amdhsa_user_sgpr_count 2
.amdhsa_user_sgpr_kernarg_segment_ptr 1
.amdhsa_system_sgpr_workgroup_id_x 1
.amdhsa_float_denorm_mode_32 3
.end_amdhsa_kernel
```
